```python
import torch

def _softmax(x, axis=-1):
    return torch.softmax(x, dim=axis)
def _gelu(x):
    return torch.nn.functional.gelu(x, approximate="tanh")
def _silu(x):
    return torch.nn.functional.silu(x)
def _sigmoid(x):
    return torch.sigmoid(x)
def _layernorm(x, axis=-1, eps=1e-5):
    m = x.mean(dim=axis, keepdim=True)
    v = x.var(dim=axis, keepdim=True, unbiased=False)
    return (x - m) / torch.sqrt(v + eps)
def _scatter_add(tgt, idx, src, axis=0):
    return tgt.clone().index_add_(axis, idx, src)
def _segment_sum(src, seg, n):
    out = torch.zeros((n,) + src.shape[1:], dtype=src.dtype)
    return out.index_add_(0, seg, src)
def _pad(x, pw):
    flat = tuple(v for pair in reversed(pw) for v in pair)
    return torch.nn.functional.pad(x, flat)

kernel_name = 'recurrent_scan__sliding_block_cached__geglu_ffn__decode'

def setup_inputs():

    _w = (lambda a: (lambda t: t.to(torch.bfloat16) if t.is_floating_point() else t)(torch.as_tensor(a)))
    def _A_setup():
        B, Sq, D = 2, 1, 640
        Hq, Hkv, Sk, Dh = 32, 32, 8192, 128
        assert Hq % Hkv == 0, (Hq, Hkv)
        return {
            "x": _w((lambda *s: torch.randn(*s, dtype=torch.bfloat16) * 0.05)(B, Sq, D)),
            "k_cache": _w((lambda *s: torch.randn(*s, dtype=torch.bfloat16) * 0.8)(B, Hkv, Sk, Dh)),
            "v_cache": _w((lambda *s: torch.randn(*s, dtype=torch.bfloat16) * 0.2)(B, Hkv, Sk, Dh)),
            "wq": _w((lambda *s: torch.randn(*s, dtype=torch.bfloat16) * 0.8)(D, Hq * Dh) * (D ** -0.5)),
            "wo": _w((lambda *s: torch.randn(*s, dtype=torch.bfloat16) * 0.2)(Hq * Dh, D) * ((Hq * Dh) ** -0.5)),
        }
    _A_in = _A_setup()

    def _B_setup():
        B, S, D, F = 2, 1, 640, 1728
        return {
            "x": _w((lambda *s: torch.randn(*s, dtype=torch.bfloat16) * 0.05)(B, S, D)),
            "w_gate": _w((lambda *s: torch.randn(*s, dtype=torch.bfloat16) * 0.1)(D, F)),
            "w_up": _w((lambda *s: torch.randn(*s, dtype=torch.bfloat16) * 0.1)(D, F)),
            "w_down": _w((lambda *s: torch.randn(*s, dtype=torch.bfloat16) * 0.1)(F, D)),
        }
    _B_in = _B_setup()

    return {
        "A_x": _A_in["x"],
        "A_k_cache": _A_in["k_cache"],
        "A_v_cache": _A_in["v_cache"],
        "A_wq": _A_in["wq"],
        "A_wo": _A_in["wo"],
        "B_x": _B_in["x"],
        "B_w_gate": _B_in["w_gate"],
        "B_w_up": _B_in["w_up"],
        "B_w_down": _B_in["w_down"],
    }

def reference(A_x, A_k_cache, A_v_cache, A_wq, A_wo, B_x, B_w_gate, B_w_up, B_w_down):
    def _A_ref(x, k_cache, v_cache, wq, wo):
        B, Sq, D = x.shape
        Hq, Dh = 32, 128
        Hkv, Sk = k_cache.shape[1], k_cache.shape[2]
        W = min(4096, max(256, Sk // 4))
        rep = Hq // Hkv
        q = (lambda x, *d: x.permute(*d))((x @ wq).reshape(B, Sq, Hq, Dh), 0, 2, 1, 3)
        k = (lambda x, n, axis: torch.repeat_interleave(x, n, dim=axis))(k_cache[:, :, Sk - W:, :], rep, axis=1)
        v = (lambda x, n, axis: torch.repeat_interleave(x, n, dim=axis))(v_cache[:, :, Sk - W:, :], rep, axis=1)
        scores = torch.einsum("bhqd,bhkd->bhqk", q, k) * (Dh ** -0.5)
        p = _softmax(scores, axis=-1)
        o = torch.einsum("bhqk,bhkd->bhqd", p, v)
        return (lambda x, *d: x.permute(*d))(o, 0, 2, 1, 3).reshape(B, Sq, Hq * Dh) @ wo

    def _B_ref(x, w_gate, w_up, w_down):
        return (_gelu(x @ w_gate) * (x @ w_up)) @ w_down

    x = A_x
    xn = _layernorm(x, axis=-1)
    s = _A_ref(xn, A_k_cache, A_v_cache, A_wq, A_wo)
    g = _silu(_B_ref(xn, B_w_gate, B_w_up, B_w_down))
    return x + s * g
```

```asm
; @launch grid=(256,1,1) block=(704,1,1) lds=45312
.amdgcn_target "amdgcn-amd-amdhsa--gfx950"
.text
.globl recurrent_scan__sliding_block_cached__geglu_ffn__decode_kernel
.p2align 12
.p2align 8
.type recurrent_scan__sliding_block_cached__geglu_ffn__decode_kernel,@function
recurrent_scan__sliding_block_cached__geglu_ffn__decode_kernel:
    s_cmp_ge_u32 s2, 256
    s_cbranch_scc1 L_end
    s_load_dwordx16 s[16:31], s[0:1], 0
    s_load_dwordx8 s[32:39], s[0:1], 64
    v_lshrrev_b32 v1, 6, v0
    s_nop 0
    v_readfirstlane_b32 s3, v1
    v_and_b32 v1, 63, v0
    v_and_b32 v2, 15, v1
    v_lshrrev_b32 v3, 4, v1
    s_and_b32 s4, s2, 31
    s_lshr_b32 s5, s2, 5
    s_cmp_eq_u32 s3, 0
    s_cbranch_scc1 L_A
    s_cmp_eq_u32 s3, 2
    s_cbranch_scc1 L_A
    s_cmp_eq_u32 s3, 1
    s_cbranch_scc1 L_B
    s_branch L_S
L_A:
    s_nop 2
    s_setprio 3
    v_mov_b32 v164, 10496
    s_and_b32 s8, s4, 7
    s_lshl_b32 s9, 1, s8
    s_cmp_eq_u32 s3, 2
    s_cbranch_scc1 L_isC_32
    s_and_b32 s9, s9, 0xa8
    s_cbranch_scc1 L_A_odd_29
    s_mov_b32 s9, s4
    s_movk_i32 s59, 0
    s_branch L_qgo_33
L_isC_32:
    s_and_b32 s9, s9, 0x45
    s_cbranch_scc0 L_A_odd_29
    s_add_u32 s9, s4, 5
    s_sub_u32 s59, s4, 3
    s_cmp_eq_u32 s8, 6
    s_cselect_b32 s9, s59, s9
    s_mov_b32 s59, 40192
L_qgo_33:
    s_mul_i32 s52, s5, 655360
    s_lshl_b32 s53, s9, 8
    s_add_u32 s52, s52, s53
    s_waitcnt lgkmcnt(0)
    s_mov_b32 s40, s16
    s_and_b32 s41, s17, 0xffff
    s_mov_b32 s42, 0xa00
    s_mov_b32 s43, 0x20000
    s_mov_b32 s48, s38
    s_and_b32 s49, s39, 0xffff
    s_mov_b32 s50, 0x140000
    s_mov_b32 s51, 0x20000
    v_mul_u32_u24 v46, 40, v1
    buffer_load_dwordx4 v[4:7], v46, s[40:43], 0 offen
    buffer_load_dwordx4 v[8:11], v46, s[40:43], 0 offen offset:16
    buffer_load_dwordx2 v[12:13], v46, s[40:43], 0 offen offset:32
    v_mov_b32 v47, 0
    buffer_load_dword v14, v47, s[48:51], 0 offen sc1
    s_mov_b32 s44, s22
    s_and_b32 s45, s23, 0xffff
    s_mov_b32 s46, 0x500000
    s_mov_b32 s47, 0x20000
    v_lshlrev_b32 v46, 13, v3
    v_lshl_add_u32 v46, v2, 4, v46
    buffer_load_dwordx4 v[48:51], v46, s[44:47], s52 offen nt
    s_add_u32 s52, s52, 32768
    buffer_load_dwordx4 v[52:55], v46, s[44:47], s52 offen nt
    s_add_u32 s52, s52, 32768
    buffer_load_dwordx4 v[56:59], v46, s[44:47], s52 offen nt
    s_add_u32 s52, s52, 32768
    buffer_load_dwordx4 v[60:63], v46, s[44:47], s52 offen nt
    s_add_u32 s52, s52, 32768
    buffer_load_dwordx4 v[64:67], v46, s[44:47], s52 offen nt
    s_add_u32 s52, s52, 32768
    buffer_load_dwordx4 v[68:71], v46, s[44:47], s52 offen nt
    s_add_u32 s52, s52, 32768
    buffer_load_dwordx4 v[72:75], v46, s[44:47], s52 offen nt
    s_add_u32 s52, s52, 32768
    buffer_load_dwordx4 v[76:79], v46, s[44:47], s52 offen nt
    s_add_u32 s52, s52, 32768
    buffer_load_dwordx4 v[80:83], v46, s[44:47], s52 offen nt
    s_add_u32 s52, s52, 32768
    buffer_load_dwordx4 v[84:87], v46, s[44:47], s52 offen nt
    s_add_u32 s52, s52, 32768
    buffer_load_dwordx4 v[88:91], v46, s[44:47], s52 offen nt
    s_add_u32 s52, s52, 32768
    buffer_load_dwordx4 v[92:95], v46, s[44:47], s52 offen nt
    s_add_u32 s52, s52, 32768
    buffer_load_dwordx4 v[96:99], v46, s[44:47], s52 offen nt
    s_add_u32 s52, s52, 32768
    buffer_load_dwordx4 v[100:103], v46, s[44:47], s52 offen nt
    s_add_u32 s52, s52, 32768
    buffer_load_dwordx4 v[104:107], v46, s[44:47], s52 offen nt
    s_add_u32 s52, s52, 32768
    buffer_load_dwordx4 v[108:111], v46, s[44:47], s52 offen nt
    s_add_u32 s52, s52, 32768
    buffer_load_dwordx4 v[112:115], v46, s[44:47], s52 offen nt
    s_add_u32 s52, s52, 32768
    buffer_load_dwordx4 v[116:119], v46, s[44:47], s52 offen nt
    s_add_u32 s52, s52, 32768
    buffer_load_dwordx4 v[120:123], v46, s[44:47], s52 offen nt
    s_add_u32 s52, s52, 32768
    buffer_load_dwordx4 v[124:127], v46, s[44:47], s52 offen nt
    ds_write_b32 v164, v47
    ds_write_b32 v164, v47 offset:12
    ds_write_b32 v164, v47 offset:20
    s_waitcnt lgkmcnt(0)
    s_barrier
    s_branch L_A_post
L_A_odd_29:
    s_waitcnt lgkmcnt(0)
    s_mov_b32 s48, s38
    s_and_b32 s49, s39, 0xffff
    s_mov_b32 s50, 0x140000
    s_mov_b32 s51, 0x20000
    v_mov_b32 v47, 0
    s_cmp_eq_u32 s3, 2
    s_cbranch_scc1 L_C_exit_34
    buffer_load_dword v14, v47, s[48:51], 0 offen sc1
    ds_write_b32 v164, v47
    ds_write_b32 v164, v47 offset:12
    ds_write_b32 v164, v47 offset:20
    s_waitcnt lgkmcnt(0)
    s_barrier
    s_waitcnt vmcnt(0)
    v_add_u32 v15, 1, v14
    v_and_b32 v15, 0xfff, v15
    s_sleep 60
    s_branch L_A_gather_30
L_C_exit_34:
    s_barrier
L_A_end_31:
    s_endpgm
L_B:
    s_nop 2
    s_setprio 3
    s_cmp_ge_u32 s4, 27
    s_cbranch_scc1 L_B_skip_37
    s_waitcnt lgkmcnt(0)
    s_mov_b32 s40, s16
    s_and_b32 s41, s17, 0xffff
    s_mov_b32 s42, 0xa00
    s_mov_b32 s43, 0x20000
    s_mov_b32 s48, s38
    s_and_b32 s49, s39, 0xffff
    s_mov_b32 s50, 0x140000
    s_mov_b32 s51, 0x20000
    v_mul_u32_u24 v46, 40, v1
    buffer_load_dwordx4 v[4:7], v46, s[40:43], 0 offen
    buffer_load_dwordx4 v[8:11], v46, s[40:43], 0 offen offset:16
    buffer_load_dwordx2 v[12:13], v46, s[40:43], 0 offen offset:32
    v_mov_b32 v47, 0
    buffer_load_dword v14, v47, s[48:51], 0 offen sc1
    s_mov_b32 s52, 0xff00ff00
    s_mov_b32 s53, 0xff00ff00
    v_mov_b32 v164, s28
    v_mov_b32 v165, s30
    v_cndmask_b32 v164, v164, v165, s[52:53]
    v_mov_b32 v165, s29
    v_mov_b32 v166, s31
    v_cndmask_b32 v165, v165, v166, s[52:53]
    v_mul_u32_u24 v46, 69120, v3
    v_and_b32 v47, 7, v1
    v_lshl_add_u32 v46, v47, 4, v46
    s_mul_i32 s54, s5, 276480
    s_lshl_b32 s55, s4, 7
    s_add_u32 s54, s54, s55
    s_add_u32 s54, s54, 3456
    v_add_u32 v46, s54, v46
    v_add_co_u32 v164, vcc, v46, v164
    s_nop 1
    v_addc_co_u32 v165, vcc, 0, v165, vcc
    global_load_dwordx4 v[48:51], v[164:165], off offset:-3456 nt
    global_load_dwordx4 v[52:55], v[164:165], off offset:0 nt
    global_load_dwordx4 v[56:59], v[164:165], off offset:3456 nt
    v_add_co_u32 v164, vcc, 10368, v164
    s_nop 1
    v_addc_co_u32 v165, vcc, 0, v165, vcc
    global_load_dwordx4 v[60:63], v[164:165], off offset:-3456 nt
    global_load_dwordx4 v[64:67], v[164:165], off offset:0 nt
    global_load_dwordx4 v[68:71], v[164:165], off offset:3456 nt
    v_add_co_u32 v164, vcc, 10368, v164
    s_nop 1
    v_addc_co_u32 v165, vcc, 0, v165, vcc
    global_load_dwordx4 v[72:75], v[164:165], off offset:-3456 nt
    global_load_dwordx4 v[76:79], v[164:165], off offset:0 nt
    global_load_dwordx4 v[80:83], v[164:165], off offset:3456 nt
    v_add_co_u32 v164, vcc, 10368, v164
    s_nop 1
    v_addc_co_u32 v165, vcc, 0, v165, vcc
    global_load_dwordx4 v[84:87], v[164:165], off offset:-3456 nt
    global_load_dwordx4 v[88:91], v[164:165], off offset:0 nt
    global_load_dwordx4 v[92:95], v[164:165], off offset:3456 nt
    v_add_co_u32 v164, vcc, 10368, v164
    s_nop 1
    v_addc_co_u32 v165, vcc, 0, v165, vcc
    global_load_dwordx4 v[96:99], v[164:165], off offset:-3456 nt
    global_load_dwordx4 v[100:103], v[164:165], off offset:0 nt
    global_load_dwordx4 v[104:107], v[164:165], off offset:3456 nt
    v_add_co_u32 v164, vcc, 10368, v164
    s_nop 1
    v_addc_co_u32 v165, vcc, 0, v165, vcc
    global_load_dwordx4 v[108:111], v[164:165], off offset:-3456 nt
    global_load_dwordx4 v[112:115], v[164:165], off offset:0 nt
    global_load_dwordx4 v[116:119], v[164:165], off offset:3456 nt
    v_add_co_u32 v164, vcc, 10368, v164
    s_nop 1
    v_addc_co_u32 v165, vcc, 0, v165, vcc
    global_load_dwordx4 v[120:123], v[164:165], off offset:-3456 nt
    global_load_dwordx4 v[124:127], v[164:165], off offset:0 nt
    s_barrier
    s_branch L_B_post
L_B_skip_37:
    s_barrier
    s_endpgm
L_S:
    s_nop 1
    s_sub_u32 s3, s3, 3
    s_lshr_b32 s6, s5, 2
    s_and_b32 s7, s5, 3
    s_lshl_b32 s56, s6, 5
    s_add_u32 s56, s56, s4
    s_lshl_b32 s56, s56, 21
    s_lshl_b32 s57, s7, 17
    s_add_u32 s56, s56, s57
    s_lshl_b32 s57, s3, 14
    s_add_u32 s56, s56, s57
    s_add_u32 s56, s56, 0x180000
    v_bfe_u32 v4, v1, 2, 2
    v_lshlrev_b32 v4, 8, v4
    v_lshl_add_u32 v4, v3, 6, v4
    v_and_b32 v5, 3, v1
    v_lshl_add_u32 v4, v5, 4, v4
    s_lshl_b32 s59, s3, 1
    s_mul_i32 s57, s5, 3
    s_add_u32 s59, s59, s57
    s_waitcnt lgkmcnt(0)
    s_mov_b32 s40, s18
    s_and_b32 s41, s19, 0xffff
    s_mov_b32 s42, 0x8000000
    s_mov_b32 s43, 0x20000
    s_barrier
    s_add_u32 s57, s59, 0
    s_and_b32 s57, s57, 15
    s_lshl_b32 s57, s57, 10
    s_add_u32 s57, s57, s56
    buffer_load_dwordx4 v[8:11], v4, s[40:43], s57 offen nt
    s_add_u32 s57, s59, 1
    s_and_b32 s57, s57, 15
    s_lshl_b32 s57, s57, 10
    s_add_u32 s57, s57, s56
    buffer_load_dwordx4 v[12:15], v4, s[40:43], s57 offen nt
    s_add_u32 s57, s59, 2
    s_and_b32 s57, s57, 15
    s_lshl_b32 s57, s57, 10
    s_add_u32 s57, s57, s56
    buffer_load_dwordx4 v[16:19], v4, s[40:43], s57 offen nt
    s_add_u32 s57, s59, 3
    s_and_b32 s57, s57, 15
    s_lshl_b32 s57, s57, 10
    s_add_u32 s57, s57, s56
    buffer_load_dwordx4 v[20:23], v4, s[40:43], s57 offen nt
    s_mov_b32 s44, s20
    s_and_b32 s45, s21, 0xffff
    s_mov_b32 s46, 0x8000000
    s_mov_b32 s47, 0x20000
    s_mov_b32 s48, s38
    s_and_b32 s49, s39, 0xffff
    s_mov_b32 s50, 0x140000
    s_mov_b32 s51, 0x20000
    s_cmp_lt_u32 s5, 5
    s_cselect_b32 s10, 1, 0
    s_sub_u32 s11, s5, 5
    s_lshl_b32 s11, s11, 1
    s_cmp_lt_u32 s4, 27
    s_cselect_b32 s60, 1, 0
    s_xor_b32 s61, s10, 1
    s_and_b32 s94, s61, s60
    s_cmp_lt_u32 s5, 7
    s_cselect_b32 s95, s94, 0
    s_cmp_lg_u32 s94, 0
    s_cselect_b32 s14, 2211840, 0
    s_cmp_lg_u32 s95, 0
    s_cselect_b32 s98, 2211840, 0
    s_cmp_lg_u32 s10, 0
    s_cselect_b32 s14, 5242880, s14
    s_cselect_b32 s98, 5242880, s98
    s_cselect_b32 s12, s24, s32
    s_cselect_b32 s13, s25, s33
    s_and_b32 s13, s13, 0xffff
    s_mov_b32 s15, 0x20000
    s_mov_b32 s96, s12
    s_mov_b32 s97, s13
    s_mov_b32 s99, 0x20000
    s_waitcnt vmcnt(3)
    s_add_u32 s57, s59, 4
    s_and_b32 s57, s57, 15
    s_lshl_b32 s57, s57, 10
    s_add_u32 s57, s57, s56
    buffer_load_dwordx4 v[24:27], v4, s[40:43], s57 offen nt
    s_waitcnt vmcnt(3)
    s_add_u32 s57, s59, 5
    s_and_b32 s57, s57, 15
    s_lshl_b32 s57, s57, 10
    s_add_u32 s57, s57, s56
    buffer_load_dwordx4 v[28:31], v4, s[40:43], s57 offen nt
    s_waitcnt vmcnt(3)
    s_add_u32 s57, s59, 6
    s_and_b32 s57, s57, 15
    s_lshl_b32 s57, s57, 10
    s_add_u32 s57, s57, s56
    buffer_load_dwordx4 v[32:35], v4, s[40:43], s57 offen nt
    s_waitcnt vmcnt(3)
    s_add_u32 s57, s59, 7
    s_and_b32 s57, s57, 15
    s_lshl_b32 s57, s57, 10
    s_add_u32 s57, s57, s56
    buffer_load_dwordx4 v[36:39], v4, s[40:43], s57 offen nt
    s_waitcnt vmcnt(3)
    s_add_u32 s57, s59, 8
    s_and_b32 s57, s57, 15
    s_lshl_b32 s57, s57, 10
    s_add_u32 s57, s57, s56
    buffer_load_dwordx4 v[40:43], v4, s[40:43], s57 offen nt
    s_waitcnt vmcnt(3)
    s_add_u32 s57, s59, 9
    s_and_b32 s57, s57, 15
    s_lshl_b32 s57, s57, 10
    s_add_u32 s57, s57, s56
    buffer_load_dwordx4 v[44:47], v4, s[40:43], s57 offen nt
    s_waitcnt vmcnt(3)
    s_add_u32 s57, s59, 10
    s_and_b32 s57, s57, 15
    s_lshl_b32 s57, s57, 10
    s_add_u32 s57, s57, s56
    buffer_load_dwordx4 v[48:51], v4, s[40:43], s57 offen nt
    s_waitcnt vmcnt(3)
    s_add_u32 s57, s59, 11
    s_and_b32 s57, s57, 15
    s_lshl_b32 s57, s57, 10
    s_add_u32 s57, s57, s56
    buffer_load_dwordx4 v[52:55], v4, s[40:43], s57 offen nt
    s_waitcnt vmcnt(3)
    s_add_u32 s57, s59, 12
    s_and_b32 s57, s57, 15
    s_lshl_b32 s57, s57, 10
    s_add_u32 s57, s57, s56
    buffer_load_dwordx4 v[56:59], v4, s[40:43], s57 offen nt
    s_waitcnt vmcnt(3)
    s_add_u32 s57, s59, 13
    s_and_b32 s57, s57, 15
    s_lshl_b32 s57, s57, 10
    s_add_u32 s57, s57, s56
    buffer_load_dwordx4 v[60:63], v4, s[40:43], s57 offen nt
    s_waitcnt vmcnt(3)
    s_add_u32 s57, s59, 14
    s_and_b32 s57, s57, 15
    s_lshl_b32 s57, s57, 10
    s_add_u32 s57, s57, s56
    buffer_load_dwordx4 v[64:67], v4, s[40:43], s57 offen nt
    s_waitcnt vmcnt(3)
    s_add_u32 s57, s59, 15
    s_and_b32 s57, s57, 15
    s_lshl_b32 s57, s57, 10
    s_add_u32 s57, s57, s56
    buffer_load_dwordx4 v[68:71], v4, s[40:43], s57 offen nt
    s_waitcnt vmcnt(3)
    s_add_u32 s57, s59, 0
    v_add_u32 v5, s57, v3
    v_and_b32 v5, 15, v5
    v_lshlrev_b32 v5, 10, v5
    v_lshl_add_u32 v5, v2, 4, v5
    buffer_load_dwordx4 v[72:75], v5, s[44:47], s56 offen offset:0 nt
    s_waitcnt vmcnt(3)
    buffer_load_dwordx4 v[76:79], v5, s[44:47], s56 offen offset:256 nt
    s_waitcnt vmcnt(3)
    buffer_load_dwordx4 v[80:83], v5, s[44:47], s56 offen offset:512 nt
    s_waitcnt vmcnt(3)
    buffer_load_dwordx4 v[84:87], v5, s[44:47], s56 offen offset:768 nt
    s_waitcnt vmcnt(3)
    s_add_u32 s57, s59, 4
    v_add_u32 v5, s57, v3
    v_and_b32 v5, 15, v5
    v_lshlrev_b32 v5, 10, v5
    v_lshl_add_u32 v5, v2, 4, v5
    buffer_load_dwordx4 v[88:91], v5, s[44:47], s56 offen offset:0 nt
    s_waitcnt vmcnt(3)
    buffer_load_dwordx4 v[92:95], v5, s[44:47], s56 offen offset:256 nt
    s_waitcnt vmcnt(3)
    buffer_load_dwordx4 v[96:99], v5, s[44:47], s56 offen offset:512 nt
    s_waitcnt vmcnt(3)
    buffer_load_dwordx4 v[100:103], v5, s[44:47], s56 offen offset:768 nt
    v_mov_b32 v6, 10496
    s_mov_b32 s58, 3200000
L_qw_1:
    ds_read_b32 v7, v6
    s_waitcnt lgkmcnt(0)
    v_cmp_eq_u32 vcc, 1, v7
    s_nop 1
    s_cbranch_vccnz L_qok_2
    s_sub_u32 s58, s58, 1
    s_cbranch_scc1 L_qok_2
    s_sleep 2
    s_branch L_qw_1
L_qok_2:
    v_and_b32 v7, 3, v1
    v_lshl_add_u32 v7, v3, 2, v7
    v_lshlrev_b32 v7, 4, v7
    ds_read_b128 v[152:155], v7 offset:10240
    ds_read_b64 v[164:165], v6 offset:4
    ds_read_b32 v167, v6 offset:16
    s_mov_b32 s62, 0xf000f
    s_mov_b32 s63, 0xf000f
    s_mov_b32 s64, 0xf000f0
    s_mov_b32 s65, 0xf000f0
    s_mov_b32 s66, 0xf000f00
    s_mov_b32 s67, 0xf000f00
    s_mov_b32 s68, 0xf000f000
    s_mov_b32 s69, 0xf000f000
    s_waitcnt lgkmcnt(0)
    v_cndmask_b32 v136, 0, v152, s[62:63]
    v_cndmask_b32 v137, 0, v153, s[62:63]
    v_cndmask_b32 v138, 0, v154, s[62:63]
    v_cndmask_b32 v139, 0, v155, s[62:63]
    v_cndmask_b32 v140, 0, v152, s[64:65]
    v_cndmask_b32 v141, 0, v153, s[64:65]
    v_cndmask_b32 v142, 0, v154, s[64:65]
    v_cndmask_b32 v143, 0, v155, s[64:65]
    v_cndmask_b32 v144, 0, v152, s[66:67]
    v_cndmask_b32 v145, 0, v153, s[66:67]
    v_cndmask_b32 v146, 0, v154, s[66:67]
    v_cndmask_b32 v147, 0, v155, s[66:67]
    v_cndmask_b32 v148, 0, v152, s[68:69]
    v_cndmask_b32 v149, 0, v153, s[68:69]
    v_cndmask_b32 v150, 0, v154, s[68:69]
    v_cndmask_b32 v151, 0, v155, s[68:69]
    v_mfma_f32_16x16x32_bf16 v[152:155], v[136:139], v[8:11], 0
    v_mfma_f32_16x16x32_bf16 v[152:155], v[140:143], v[12:15], v[152:155]
    v_mfma_f32_16x16x32_bf16 v[152:155], v[144:147], v[16:19], v[152:155]
    v_mfma_f32_16x16x32_bf16 v[152:155], v[148:151], v[20:23], v[152:155]
    s_waitcnt vmcnt(3)
    s_add_u32 s57, s59, 8
    v_add_u32 v5, s57, v3
    v_and_b32 v5, 15, v5
    v_lshlrev_b32 v5, 10, v5
    v_lshl_add_u32 v5, v2, 4, v5
    buffer_load_dwordx4 v[104:107], v5, s[44:47], s56 offen offset:0 nt
    v_mfma_f32_16x16x32_bf16 v[156:159], v[136:139], v[24:27], 0
    v_mfma_f32_16x16x32_bf16 v[156:159], v[140:143], v[28:31], v[156:159]
    v_mfma_f32_16x16x32_bf16 v[156:159], v[144:147], v[32:35], v[156:159]
    v_mfma_f32_16x16x32_bf16 v[156:159], v[148:151], v[36:39], v[156:159]
    s_waitcnt vmcnt(3)
    buffer_load_dwordx4 v[108:111], v5, s[44:47], s56 offen offset:256 nt
    v_mov_b32_dpp v160, v152 quad_perm:[0,0,0,0] row_mask:0xf bank_mask:0xf
    v_mov_b32_dpp v6, v154 quad_perm:[2,2,2,2] row_mask:0xf bank_mask:0xf
    s_nop 0
    v_add_f32_dpp v160, v153, v160 quad_perm:[1,1,1,1] row_mask:0xf bank_mask:0xf
    v_add_f32_dpp v6, v155, v6 quad_perm:[3,3,3,3] row_mask:0xf bank_mask:0xf
    v_add_f32 v160, v160, v6
    v_mfma_f32_16x16x32_bf16 v[152:155], v[136:139], v[40:43], 0
    v_mfma_f32_16x16x32_bf16 v[152:155], v[140:143], v[44:47], v[152:155]
    v_mfma_f32_16x16x32_bf16 v[152:155], v[144:147], v[48:51], v[152:155]
    v_mfma_f32_16x16x32_bf16 v[152:155], v[148:151], v[52:55], v[152:155]
    s_waitcnt vmcnt(3)
    buffer_load_dwordx4 v[112:115], v5, s[44:47], s56 offen offset:512 nt
    v_mov_b32_dpp v161, v156 quad_perm:[0,0,0,0] row_mask:0xf bank_mask:0xf
    v_mov_b32_dpp v6, v158 quad_perm:[2,2,2,2] row_mask:0xf bank_mask:0xf
    s_nop 0
    v_add_f32_dpp v161, v157, v161 quad_perm:[1,1,1,1] row_mask:0xf bank_mask:0xf
    v_add_f32_dpp v6, v159, v6 quad_perm:[3,3,3,3] row_mask:0xf bank_mask:0xf
    v_add_f32 v161, v161, v6
    v_mfma_f32_16x16x32_bf16 v[156:159], v[136:139], v[56:59], 0
    v_mfma_f32_16x16x32_bf16 v[156:159], v[140:143], v[60:63], v[156:159]
    v_mfma_f32_16x16x32_bf16 v[156:159], v[144:147], v[64:67], v[156:159]
    v_mfma_f32_16x16x32_bf16 v[156:159], v[148:151], v[68:71], v[156:159]
    s_waitcnt vmcnt(3)
    buffer_load_dwordx4 v[116:119], v5, s[44:47], s56 offen offset:768 nt
    v_mov_b32_dpp v162, v152 quad_perm:[0,0,0,0] row_mask:0xf bank_mask:0xf
    v_mov_b32_dpp v6, v154 quad_perm:[2,2,2,2] row_mask:0xf bank_mask:0xf
    s_nop 0
    v_add_f32_dpp v162, v153, v162 quad_perm:[1,1,1,1] row_mask:0xf bank_mask:0xf
    v_add_f32_dpp v6, v155, v6 quad_perm:[3,3,3,3] row_mask:0xf bank_mask:0xf
    v_add_f32 v162, v162, v6
    v_mov_b32_dpp v163, v156 quad_perm:[0,0,0,0] row_mask:0xf bank_mask:0xf
    v_mov_b32_dpp v6, v158 quad_perm:[2,2,2,2] row_mask:0xf bank_mask:0xf
    s_nop 0
    v_add_f32_dpp v163, v157, v163 quad_perm:[1,1,1,1] row_mask:0xf bank_mask:0xf
    v_add_f32_dpp v6, v159, v6 quad_perm:[3,3,3,3] row_mask:0xf bank_mask:0xf
    v_add_f32 v163, v163, v6
    v_cvt_pk_bf16_f32 v6, v160, v161
    v_cvt_pk_bf16_f32 v7, v162, v163
    v_lshlrev_b32 v160, 16, v6
    v_and_b32 v161, 0xffff0000, v6
    v_lshlrev_b32 v162, 16, v7
    v_and_b32 v163, 0xffff0000, v7
    v_mul_f32 v160, 0x3db504f3, v160
    v_mul_f32 v161, 0x3db504f3, v161
    v_mul_f32 v162, 0x3db504f3, v162
    v_mul_f32 v163, 0x3db504f3, v163
    v_cvt_pk_bf16_f32 v6, v160, v161
    v_cvt_pk_bf16_f32 v7, v162, v163
    v_lshlrev_b32 v160, 16, v6
    v_and_b32 v161, 0xffff0000, v6
    v_lshlrev_b32 v162, 16, v7
    v_and_b32 v163, 0xffff0000, v7
    v_max3_f32 v6, v160, v161, v162
    v_max_f32 v6, v6, v163
    s_nop 1
    v_max_f32_dpp v6, v6, v6 row_ror:4 row_mask:0xf bank_mask:0xf
    s_nop 1
    v_max_f32_dpp v6, v6, v6 row_ror:8 row_mask:0xf bank_mask:0xf
    v_mov_b32 v7, v6
    s_nop 1
    v_permlane16_swap_b32 v6, v7
    v_max_f32 v6, v6, v7
    v_mov_b32 v7, v6
    s_nop 1
    v_permlane32_swap_b32 v6, v7
    v_max_f32 v6, v6, v7
    s_lshl_b32 s57, s3, 2
    v_mov_b32 v7, s57
    s_mov_b64 exec, 1
    ds_write_b32 v7, v6 offset:10528
    v_mov_b32 v7, 10496
    v_mov_b32 v6, 1
    ds_add_u32 v7, v6 offset:12
    s_mov_b64 exec, -1
    s_waitcnt vmcnt(3)
    s_add_u32 s57, s59, 12
    v_add_u32 v5, s57, v3
    v_and_b32 v5, 15, v5
    v_lshlrev_b32 v5, 10, v5
    v_lshl_add_u32 v5, v2, 4, v5
    buffer_load_dwordx4 v[120:123], v5, s[44:47], s56 offen offset:0 nt
    s_waitcnt vmcnt(3)
    buffer_load_dwordx4 v[124:127], v5, s[44:47], s56 offen offset:256 nt
    s_waitcnt vmcnt(3)
    buffer_load_dwordx4 v[128:131], v5, s[44:47], s56 offen offset:512 nt
    s_waitcnt vmcnt(3)
    buffer_load_dwordx4 v[132:135], v5, s[44:47], s56 offen offset:768 nt
    v_readfirstlane_b32 s100, v167
    s_lshl_b32 s57, s4, 3
    s_add_u32 s57, s57, s3
    s_mul_i32 s52, s57, 20480
    s_lshl_b32 s58, s5, 8
    s_add_u32 s52, s52, s58
    s_mul_i32 s58, s57, 10240
    s_lshl_b32 s61, s11, 8
    s_add_u32 s58, s58, s61
    s_cmp_lg_u32 s10, 0
    s_cselect_b32 s52, s52, s58
    s_movk_i32 s61, 5120
    s_cselect_b32 s53, 1280, s61
    s_movk_i32 s61, 256
    s_cselect_b32 s54, 2560, s61
    s_movk_i32 s61, 5376
    s_cselect_b32 s55, 3840, s61
    s_movk_i32 s61, 1280
    s_cselect_b32 s61, 5120, s61
    s_add_u32 s53, s53, s52
    s_add_u32 s54, s54, s52
    s_add_u32 s55, s55, s52
    v_mul_lo_u32 v167, s61, v3
    v_lshl_add_u32 v167, v2, 4, v167
    v_and_b32 v148, 1, v1
    v_cmp_eq_u32 vcc, 1, v148
    v_mov_b32 v148, 0xffff
    v_mov_b32 v149, 0xffff0000
    v_cndmask_b32 v148, v148, v149, vcc
    v_bfe_u32 v149, v1, 1, 2
    v_cmp_eq_u32 vcc, 0, v149
    s_nop 1
    v_cndmask_b32 v136, 0, v148, vcc
    v_cmp_eq_u32 vcc, 1, v149
    s_nop 1
    v_cndmask_b32 v137, 0, v148, vcc
    v_cmp_eq_u32 vcc, 2, v149
    s_nop 1
    v_cndmask_b32 v138, 0, v148, vcc
    v_cmp_eq_u32 vcc, 3, v149
    s_nop 1
    v_cndmask_b32 v139, 0, v148, vcc
    s_mov_b32 s58, 3200000
    v_mov_b32 v7, 10496
L_mw_3:
    ds_read_b32 v6, v7 offset:12
    s_waitcnt lgkmcnt(0)
    v_cmp_eq_u32 vcc, 8, v6
    s_nop 1
    s_cbranch_vccnz L_mok_4
    s_sub_u32 s58, s58, 1
    s_cbranch_scc1 L_mok_4
    s_sleep 1
    s_branch L_mw_3
L_mok_4:
    v_mov_b32 v7, 0
    ds_read_b128 v[140:143], v7 offset:10528
    ds_read_b128 v[144:147], v7 offset:10544
    s_waitcnt lgkmcnt(0)
    v_max3_f32 v6, v140, v141, v142
    v_max3_f32 v7, v143, v144, v145
    v_max3_f32 v6, v6, v146, v147
    v_max_f32 v166, v6, v7
    v_sub_f32 v160, v160, v166
    v_sub_f32 v161, v161, v166
    v_sub_f32 v162, v162, v166
    v_sub_f32 v163, v163, v166
    v_mul_f32 v160, 0x3fb8aa3b, v160
    v_mul_f32 v161, 0x3fb8aa3b, v161
    v_mul_f32 v162, 0x3fb8aa3b, v162
    v_mul_f32 v163, 0x3fb8aa3b, v163
    v_exp_f32 v160, v160
    v_exp_f32 v161, v161
    v_exp_f32 v162, v162
    v_exp_f32 v163, v163
    v_add_f32 v156, v160, v161
    v_add_f32 v6, v162, v163
    v_add_f32 v156, v156, v6
    v_cvt_pk_bf16_f32 v160, v160, v160
    v_cvt_pk_bf16_f32 v161, v161, v161
    v_cvt_pk_bf16_f32 v162, v162, v162
    v_cvt_pk_bf16_f32 v163, v163, v163
    v_add_f32_dpp v156, v156, v156 row_ror:4 row_mask:0xf bank_mask:0xf
    s_nop 1
    v_add_f32_dpp v156, v156, v156 row_ror:8 row_mask:0xf bank_mask:0xf
    v_mov_b32 v7, v156
    s_nop 1
    v_permlane16_swap_b32 v156, v7
    v_add_f32 v156, v156, v7
    v_mov_b32 v7, v156
    s_nop 1
    v_permlane32_swap_b32 v156, v7
    v_add_f32 v156, v156, v7
    s_lshl_b32 s57, s3, 2
    v_mov_b32 v7, s57
    s_mov_b64 exec, 1
    ds_write_b32 v7, v156 offset:10560
    s_mov_b64 exec, -1
    v_and_b32 v4, 16, v1
    v_lshl_add_u32 v4, v2, 5, v4
    s_lshl_b32 s57, s3, 9
    v_add_u32 v4, s57, v4
    v_lshrrev_b32 v6, 5, v1
    v_lshlrev_b32 v5, 9, v6
    v_and_b32 v6, 15, v1
    v_lshl_add_u32 v5, v6, 5, v5
    v_and_b32 v6, 16, v1
    v_add_u32 v5, v5, v6
    s_mov_b32 s60, 0xfffff000
    v_lshrrev_b32 v148, 3, v1
    v_lshlrev_b32 v148, 9, v148
    v_and_b32 v6, 7, v1
    v_lshl_add_u32 v148, v6, 3, v148
    s_lshl_b32 s57, s3, 6
    v_add_u32 v148, s57, v148
    v_mov_b32 v151, 0
    v_bfe_u32 v40, v1, 3, 1
    v_lshlrev_b32 v40, 12, v40
    v_and_b32 v41, 3, v1
    v_lshl_add_u32 v40, v41, 4, v40
    v_lshlrev_b32 v41, 6, v3
    v_mov_b32 v44, 0x100
    s_mov_b32 s68, 0xf0f0f0f0
    s_mov_b32 s69, 0xf0f0f0f0
    v_cndmask_b32 v41, v41, v44, s[68:69]
    v_add_u32 v40, v40, v41
    s_lshl_b32 s68, s4, 13
    s_lshl_b32 s57, s3, 9
    s_add_u32 s68, s68, s57
    s_add_u32 s68, s68, 0x90000
    v_lshlrev_b32 v42, 4, v1
    s_lshl_b32 s57, s3, 10
    v_add_u32 v43, s57, v5
    s_lshl_b32 s69, s5, 5
    s_add_u32 s69, s69, s4
    s_lshl_b32 s69, s69, 10
    s_add_u32 s69, s69, 0xd0000
    v_bfe_u32 v150, v1, 3, 1
    v_lshlrev_b32 v150, 8, v150
    v_lshl_add_u32 v150, v3, 2, v150
    s_lshl_b32 s57, s3, 5
    s_add_u32 s57, s57, 10752
    v_add_u32 v150, s57, v150
    v_bfe_u32 v7, v1, 4, 1
    v_lshl_add_u32 v149, v6, 1, v7
    v_and_b32 v7, 3, v149
    v_lshrrev_b32 v149, 2, v149
    v_lshlrev_b32 v149, 6, v149
    v_lshl_add_u32 v149, v7, 2, v149
    v_and_b32 v7, 3, v1
    v_lshlrev_b32 v7, 2, v7
    v_add_u32 v7, 0x100, v7
    s_mov_b32 s64, 0
    s_mov_b32 s65, -1
    v_cndmask_b32 v149, v149, v7, s[64:65]
    s_mov_b32 s62, 0xaaaaaaaa
    s_mov_b32 s63, 0xaaaaaaaa
    s_mov_b32 s66, 0x00ff00ff
    s_mov_b32 s67, 0xf
    s_lshl_b32 s101, s4, 1
    s_add_u32 s101, s101, s6
    s_lshl_b32 s101, s101, 3
    s_add_u32 s101, s101, s3
    s_lshl_b32 s101, s101, 9
    s_lshl_b32 s57, s7, 4
    s_add_u32 s101, s101, s57
    s_add_u32 s101, s101, 0x90000
    v_and_b32_dpp v140, v160, v136 row_newbcast:0 row_mask:0xf bank_mask:0xf
    v_and_b32_dpp v141, v160, v137 row_newbcast:0 row_mask:0xf bank_mask:0xf
    v_and_b32_dpp v142, v160, v138 row_newbcast:0 row_mask:0xf bank_mask:0xf
    v_and_b32_dpp v143, v160, v139 row_newbcast:0 row_mask:0xf bank_mask:0xf
    v_and_b32_dpp v144, v160, v136 row_newbcast:4 row_mask:0xf bank_mask:0xf
    v_and_b32_dpp v145, v160, v137 row_newbcast:4 row_mask:0xf bank_mask:0xf
    v_and_b32_dpp v146, v160, v138 row_newbcast:4 row_mask:0xf bank_mask:0xf
    v_and_b32_dpp v147, v160, v139 row_newbcast:4 row_mask:0xf bank_mask:0xf
    s_waitcnt vmcnt(15)
    v_mfma_f32_16x16x32_bf16 v[152:155], v[140:143], v[72:75], 0
    v_and_b32_dpp v140, v160, v136 row_newbcast:8 row_mask:0xf bank_mask:0xf
    v_and_b32_dpp v141, v160, v137 row_newbcast:8 row_mask:0xf bank_mask:0xf
    v_and_b32_dpp v142, v160, v138 row_newbcast:8 row_mask:0xf bank_mask:0xf
    v_and_b32_dpp v143, v160, v139 row_newbcast:8 row_mask:0xf bank_mask:0xf
    s_waitcnt vmcnt(14)
    v_mfma_f32_16x16x32_bf16 v[152:155], v[144:147], v[76:79], v[152:155]
    v_and_b32_dpp v144, v160, v136 row_newbcast:12 row_mask:0xf bank_mask:0xf
    v_and_b32_dpp v145, v160, v137 row_newbcast:12 row_mask:0xf bank_mask:0xf
    v_and_b32_dpp v146, v160, v138 row_newbcast:12 row_mask:0xf bank_mask:0xf
    v_and_b32_dpp v147, v160, v139 row_newbcast:12 row_mask:0xf bank_mask:0xf
    s_waitcnt vmcnt(13)
    v_mfma_f32_16x16x32_bf16 v[152:155], v[140:143], v[80:83], v[152:155]
    v_and_b32_dpp v140, v161, v136 row_newbcast:0 row_mask:0xf bank_mask:0xf
    v_and_b32_dpp v141, v161, v137 row_newbcast:0 row_mask:0xf bank_mask:0xf
    v_and_b32_dpp v142, v161, v138 row_newbcast:0 row_mask:0xf bank_mask:0xf
    v_and_b32_dpp v143, v161, v139 row_newbcast:0 row_mask:0xf bank_mask:0xf
    s_waitcnt vmcnt(12)
    v_mfma_f32_16x16x32_bf16 v[152:155], v[144:147], v[84:87], v[152:155]
    v_and_b32_dpp v144, v161, v136 row_newbcast:4 row_mask:0xf bank_mask:0xf
    v_and_b32_dpp v145, v161, v137 row_newbcast:4 row_mask:0xf bank_mask:0xf
    v_and_b32_dpp v146, v161, v138 row_newbcast:4 row_mask:0xf bank_mask:0xf
    v_and_b32_dpp v147, v161, v139 row_newbcast:4 row_mask:0xf bank_mask:0xf
    s_waitcnt vmcnt(11)
    v_mfma_f32_16x16x32_bf16 v[152:155], v[140:143], v[88:91], v[152:155]
    buffer_load_dwordx4 v[8:11], v167, s[12:15], s52 offen nt
    v_and_b32_dpp v140, v161, v136 row_newbcast:8 row_mask:0xf bank_mask:0xf
    v_and_b32_dpp v141, v161, v137 row_newbcast:8 row_mask:0xf bank_mask:0xf
    v_and_b32_dpp v142, v161, v138 row_newbcast:8 row_mask:0xf bank_mask:0xf
    v_and_b32_dpp v143, v161, v139 row_newbcast:8 row_mask:0xf bank_mask:0xf
    s_waitcnt vmcnt(11)
    v_mfma_f32_16x16x32_bf16 v[152:155], v[144:147], v[92:95], v[152:155]
    buffer_load_dwordx4 v[12:15], v167, s[12:15], s53 offen nt
    v_and_b32_dpp v144, v161, v136 row_newbcast:12 row_mask:0xf bank_mask:0xf
    v_and_b32_dpp v145, v161, v137 row_newbcast:12 row_mask:0xf bank_mask:0xf
    v_and_b32_dpp v146, v161, v138 row_newbcast:12 row_mask:0xf bank_mask:0xf
    v_and_b32_dpp v147, v161, v139 row_newbcast:12 row_mask:0xf bank_mask:0xf
    s_waitcnt vmcnt(11)
    v_mfma_f32_16x16x32_bf16 v[152:155], v[140:143], v[96:99], v[152:155]
    buffer_load_dwordx4 v[16:19], v167, s[96:99], s54 offen nt
    v_and_b32_dpp v140, v162, v136 row_newbcast:0 row_mask:0xf bank_mask:0xf
    v_and_b32_dpp v141, v162, v137 row_newbcast:0 row_mask:0xf bank_mask:0xf
    v_and_b32_dpp v142, v162, v138 row_newbcast:0 row_mask:0xf bank_mask:0xf
    v_and_b32_dpp v143, v162, v139 row_newbcast:0 row_mask:0xf bank_mask:0xf
    s_waitcnt vmcnt(11)
    v_mfma_f32_16x16x32_bf16 v[152:155], v[144:147], v[100:103], v[152:155]
    buffer_load_dwordx4 v[20:23], v167, s[96:99], s55 offen nt
    v_and_b32_dpp v144, v162, v136 row_newbcast:4 row_mask:0xf bank_mask:0xf
    v_and_b32_dpp v145, v162, v137 row_newbcast:4 row_mask:0xf bank_mask:0xf
    v_and_b32_dpp v146, v162, v138 row_newbcast:4 row_mask:0xf bank_mask:0xf
    v_and_b32_dpp v147, v162, v139 row_newbcast:4 row_mask:0xf bank_mask:0xf
    s_waitcnt vmcnt(11)
    v_mfma_f32_16x16x32_bf16 v[152:155], v[140:143], v[104:107], v[152:155]
    v_and_b32_dpp v140, v162, v136 row_newbcast:8 row_mask:0xf bank_mask:0xf
    v_and_b32_dpp v141, v162, v137 row_newbcast:8 row_mask:0xf bank_mask:0xf
    v_and_b32_dpp v142, v162, v138 row_newbcast:8 row_mask:0xf bank_mask:0xf
    v_and_b32_dpp v143, v162, v139 row_newbcast:8 row_mask:0xf bank_mask:0xf
    s_waitcnt vmcnt(10)
    v_mfma_f32_16x16x32_bf16 v[152:155], v[144:147], v[108:111], v[152:155]
    v_and_b32_dpp v144, v162, v136 row_newbcast:12 row_mask:0xf bank_mask:0xf
    v_and_b32_dpp v145, v162, v137 row_newbcast:12 row_mask:0xf bank_mask:0xf
    v_and_b32_dpp v146, v162, v138 row_newbcast:12 row_mask:0xf bank_mask:0xf
    v_and_b32_dpp v147, v162, v139 row_newbcast:12 row_mask:0xf bank_mask:0xf
    s_waitcnt vmcnt(9)
    v_mfma_f32_16x16x32_bf16 v[152:155], v[140:143], v[112:115], v[152:155]
    v_and_b32_dpp v140, v163, v136 row_newbcast:0 row_mask:0xf bank_mask:0xf
    v_and_b32_dpp v141, v163, v137 row_newbcast:0 row_mask:0xf bank_mask:0xf
    v_and_b32_dpp v142, v163, v138 row_newbcast:0 row_mask:0xf bank_mask:0xf
    v_and_b32_dpp v143, v163, v139 row_newbcast:0 row_mask:0xf bank_mask:0xf
    s_waitcnt vmcnt(8)
    v_mfma_f32_16x16x32_bf16 v[152:155], v[144:147], v[116:119], v[152:155]
    v_and_b32_dpp v144, v163, v136 row_newbcast:4 row_mask:0xf bank_mask:0xf
    v_and_b32_dpp v145, v163, v137 row_newbcast:4 row_mask:0xf bank_mask:0xf
    v_and_b32_dpp v146, v163, v138 row_newbcast:4 row_mask:0xf bank_mask:0xf
    v_and_b32_dpp v147, v163, v139 row_newbcast:4 row_mask:0xf bank_mask:0xf
    s_waitcnt vmcnt(7)
    v_mfma_f32_16x16x32_bf16 v[152:155], v[140:143], v[120:123], v[152:155]
    v_and_b32_dpp v140, v163, v136 row_newbcast:8 row_mask:0xf bank_mask:0xf
    v_and_b32_dpp v141, v163, v137 row_newbcast:8 row_mask:0xf bank_mask:0xf
    v_and_b32_dpp v142, v163, v138 row_newbcast:8 row_mask:0xf bank_mask:0xf
    v_and_b32_dpp v143, v163, v139 row_newbcast:8 row_mask:0xf bank_mask:0xf
    s_waitcnt vmcnt(6)
    v_mfma_f32_16x16x32_bf16 v[152:155], v[144:147], v[124:127], v[152:155]
    v_and_b32_dpp v144, v163, v136 row_newbcast:12 row_mask:0xf bank_mask:0xf
    v_and_b32_dpp v145, v163, v137 row_newbcast:12 row_mask:0xf bank_mask:0xf
    v_and_b32_dpp v146, v163, v138 row_newbcast:12 row_mask:0xf bank_mask:0xf
    v_and_b32_dpp v147, v163, v139 row_newbcast:12 row_mask:0xf bank_mask:0xf
    s_waitcnt vmcnt(5)
    v_mfma_f32_16x16x32_bf16 v[152:155], v[140:143], v[128:131], v[152:155]
    s_waitcnt vmcnt(4)
    v_mfma_f32_16x16x32_bf16 v[152:155], v[144:147], v[132:135], v[152:155]
    s_nop 7
    ds_write_b128 v4, v[152:155] offset:11264
    s_waitcnt lgkmcnt(0)
    s_barrier
    ds_read_b64 v[72:73], v148 offset:11264
    ds_read_b128 v[76:79], v151 offset:10560
    ds_read_b128 v[80:83], v151 offset:10576
    ds_read2_b32 v[84:85], v150 offset0:0 offset1:4
    s_waitcnt lgkmcnt(3)
    v_add_f32_dpp v72, v72, v72 row_ror:8 row_mask:0xf bank_mask:0xf
    v_add_f32_dpp v73, v73, v73 row_ror:8 row_mask:0xf bank_mask:0xf
    s_nop 1
    v_permlane16_swap_b32 v72, v73
    s_waitcnt lgkmcnt(1)
    v_pk_add_f32 v[76:77], v[76:77], v[78:79]
    v_add_f32 v72, v72, v73
    v_pk_add_f32 v[80:81], v[80:81], v[82:83]
    v_mov_b32 v73, v72
    v_pk_add_f32 v[76:77], v[76:77], v[80:81]
    s_nop 0
    v_permlane32_swap_b32 v72, v73
    v_add_f32 v76, v76, v77
    v_add_f32 v72, v72, v73
    v_cndmask_b32 v77, v166, v76, s[62:63]
    v_cndmask_b32 v72, v72, v77, s[64:65]
    v_add_u32 v72, 0x800, v72
    v_and_or_b32 v72, v72, s60, v164
    s_mov_b64 exec, s[66:67]
    s_cmp_eq_u32 s100, 0
    s_cbranch_scc1 L_o2_glob_5
    buffer_store_dword v72, v149, s[48:51], s101 offen
L_o2_done_6:
    s_mov_b64 exec, -1
    s_waitcnt lgkmcnt(0)
    s_nop 1
    s_cmp_eq_u32 s94, 0
    s_cbranch_scc1 L_nowd_7
    v_and_b32 v140, v84, v136
    v_and_b32 v141, v84, v137
    v_and_b32 v142, v84, v138
    v_and_b32 v143, v84, v139
    v_and_b32 v144, v85, v136
    v_and_b32 v145, v85, v137
    v_and_b32 v146, v85, v138
    v_and_b32 v147, v85, v139
    v_lshlrev_b32 v4, 4, v1
    s_cmp_eq_u32 s3, 2
    s_cselect_b32 s58, 1, 0
    s_lshl_b32 s61, s58, 13
    s_add_u32 s61, s61, 23552
    s_add_u32 s58, s58, s11
    v_add_u32 v7, s61, v4
    s_lshl_b32 s58, s58, 5
    s_add_u32 s58, s58, s4
    s_lshl_b32 s58, s58, 10
    s_add_u32 s57, s58, 0x100000
    s_waitcnt vmcnt(1)
    v_mfma_f32_16x16x32_bf16 v[152:155], v[140:143], v[8:11], 0
    v_mfma_f32_16x16x32_bf16 v[156:159], v[140:143], v[16:19], 0
    v_mfma_f32_16x16x32_bf16 v[152:155], v[144:147], v[12:15], v[152:155]
    v_mfma_f32_16x16x32_bf16 v[156:159], v[144:147], v[20:23], v[156:159]
    s_lshl_b32 s61, s3, 10
    v_add_u32 v6, s61, v5
    s_nop 4
    ds_write_b128 v6, v[152:155] offset:23552
    ds_write_b128 v6, v[156:159] offset:31744
    s_waitcnt lgkmcnt(0)
    s_barrier
    s_cmp_eq_u32 s3, 1
    s_cbranch_scc1 L_wdpub_8
    s_cmp_lg_u32 s3, 2
    s_cbranch_scc1 L_nowd_7
    s_cmp_eq_u32 s95, 0
    s_cbranch_scc1 L_nowd_7
L_wdpub_8:
    ds_read_b128 v[72:75], v7 offset:0
    ds_read_b128 v[76:79], v7 offset:1024
    ds_read_b128 v[80:83], v7 offset:2048
    ds_read_b128 v[84:87], v7 offset:3072
    ds_read_b128 v[88:91], v7 offset:4096
    ds_read_b128 v[92:95], v7 offset:5120
    ds_read_b128 v[96:99], v7 offset:6144
    ds_read_b128 v[100:103], v7 offset:7168
    s_waitcnt lgkmcnt(6)
    v_pk_add_f32 v[72:73], v[72:73], v[76:77]
    v_pk_add_f32 v[74:75], v[74:75], v[78:79]
    s_waitcnt lgkmcnt(4)
    v_pk_add_f32 v[80:81], v[80:81], v[84:85]
    v_pk_add_f32 v[82:83], v[82:83], v[86:87]
    s_waitcnt lgkmcnt(2)
    v_pk_add_f32 v[88:89], v[88:89], v[92:93]
    v_pk_add_f32 v[90:91], v[90:91], v[94:95]
    v_pk_add_f32 v[72:73], v[72:73], v[80:81]
    v_pk_add_f32 v[74:75], v[74:75], v[82:83]
    s_waitcnt lgkmcnt(0)
    v_pk_add_f32 v[96:97], v[96:97], v[100:101]
    v_pk_add_f32 v[98:99], v[98:99], v[102:103]
    v_pk_add_f32 v[88:89], v[88:89], v[96:97]
    v_pk_add_f32 v[90:91], v[90:91], v[98:99]
    v_pk_add_f32 v[72:73], v[72:73], v[88:89]
    v_pk_add_f32 v[74:75], v[74:75], v[90:91]
    v_add_u32 v72, 0x800, v72
    v_add_u32 v73, 0x800, v73
    v_add_u32 v74, 0x800, v74
    v_add_u32 v75, 0x800, v75
    v_and_or_b32 v72, v72, s60, v164
    v_and_or_b32 v73, v73, s60, v164
    v_and_or_b32 v74, v74, s60, v164
    v_and_or_b32 v75, v75, s60, v164
    buffer_store_dwordx4 v[72:75], v4, s[48:51], s57 offen sc1
    s_nop 1
L_nowd_7:
    s_nop 2
    s_cmp_eq_u32 s10, 0
    s_cbranch_scc1 L_red_9
    s_mov_b32 s58, 400000
    s_mov_b64 s[62:63], -1
    s_mov_b64 s[64:65], s[62:63]
    s_mov_b64 exec, s[62:63]
    buffer_load_dwordx4 v[88:91], v40, s[48:51], s68 offen sc1
    s_sleep 2
    s_nop 2
L_mp_o_11:
    s_mov_b64 s[66:67], s[62:63]
    s_mov_b64 exec, s[62:63]
    buffer_load_dwordx4 v[92:95], v40, s[48:51], s68 offen sc1
    s_waitcnt vmcnt(1)
    s_mov_b64 exec, s[64:65]
    v_xor_b32 v88, v88, v164
    v_xor_b32 v89, v89, v164
    v_xor_b32 v90, v90, v164
    v_xor_b32 v91, v91, v164
    v_or3_b32 v7, v88, v89, v90
    v_or_b32 v7, v7, v91
    v_and_b32 v7, 0xfff, v7
    v_cmp_eq_u32 vcc, 0, v7
    s_nop 0
    s_and_b64 exec, exec, vcc
    v_mov_b32 v72, v88
    v_mov_b32 v73, v89
    v_mov_b32 v74, v90
    v_mov_b32 v75, v91
    s_andn2_b64 s[62:63], s[62:63], vcc
    s_cbranch_scc0 L_mp_done_o_10
    s_sub_u32 s58, s58, 1
    s_cbranch_scc1 L_mp_done_o_10
    s_bcnt1_i32_b64 s59, s[62:63]
    s_cmp_le_u32 s59, 64
    s_cbranch_scc1 L_mp_fast_12
    s_sleep 8
L_mp_fast_12:
    s_mov_b64 s[64:65], s[62:63]
    s_mov_b64 exec, s[62:63]
    buffer_load_dwordx4 v[88:91], v40, s[48:51], s68 offen sc1
    s_waitcnt vmcnt(1)
    s_mov_b64 exec, s[66:67]
    v_xor_b32 v92, v92, v164
    v_xor_b32 v93, v93, v164
    v_xor_b32 v94, v94, v164
    v_xor_b32 v95, v95, v164
    v_or3_b32 v7, v92, v93, v94
    v_or_b32 v7, v7, v95
    v_and_b32 v7, 0xfff, v7
    v_cmp_eq_u32 vcc, 0, v7
    s_nop 0
    s_and_b64 exec, exec, vcc
    v_mov_b32 v72, v92
    v_mov_b32 v73, v93
    v_mov_b32 v74, v94
    v_mov_b32 v75, v95
    s_andn2_b64 s[62:63], s[62:63], vcc
    s_cbranch_scc0 L_mp_done_o_10
    s_sub_u32 s58, s58, 1
    s_cbranch_scc1 L_mp_done_o_10
    s_bcnt1_i32_b64 s59, s[62:63]
    s_cmp_le_u32 s59, 64
    s_cbranch_scc1 L_mp_fast_13
    s_sleep 8
L_mp_fast_13:
    s_branch L_mp_o_11
L_mp_done_o_10:
    s_mov_b64 exec, -1
    s_nop 1
    v_max_f32_dpp v80, v72, v72 quad_perm:[1,0,3,2] row_mask:0xf bank_mask:0xf
    s_nop 1
    v_max_f32_dpp v80, v80, v80 quad_perm:[2,3,0,1] row_mask:0xf bank_mask:0xf
    v_sub_f32 v81, v72, v80
    v_mul_f32 v81, 0x3fb8aa3b, v81
    v_exp_f32 v81, v81
    s_nop 0
    v_mul_f32 v82, v81, v73
    v_mov_b32_dpp v80, v81 row_shl:4 row_mask:0xf bank_mask:0x5
    s_nop 0
    v_add_f32_dpp v82, v82, v82 quad_perm:[1,0,3,2] row_mask:0xf bank_mask:0xf
    v_mul_f32 v72, v72, v80
    v_mul_f32 v73, v73, v80
    v_mul_f32 v74, v74, v80
    v_mul_f32 v75, v75, v80
    v_add_f32_dpp v82, v82, v82 quad_perm:[2,3,0,1] row_mask:0xf bank_mask:0xf
    v_add_f32_dpp v72, v72, v72 quad_perm:[1,0,3,2] row_mask:0xf bank_mask:0xf
    v_add_f32_dpp v73, v73, v73 quad_perm:[1,0,3,2] row_mask:0xf bank_mask:0xf
    v_add_f32_dpp v74, v74, v74 quad_perm:[1,0,3,2] row_mask:0xf bank_mask:0xf
    v_add_f32_dpp v75, v75, v75 quad_perm:[1,0,3,2] row_mask:0xf bank_mask:0xf
    v_rcp_f32 v82, v82
    v_add_f32_dpp v72, v72, v72 quad_perm:[2,3,0,1] row_mask:0xf bank_mask:0xf
    v_add_f32_dpp v73, v73, v73 quad_perm:[2,3,0,1] row_mask:0xf bank_mask:0xf
    v_add_f32_dpp v74, v74, v74 quad_perm:[2,3,0,1] row_mask:0xf bank_mask:0xf
    v_add_f32_dpp v75, v75, v75 quad_perm:[2,3,0,1] row_mask:0xf bank_mask:0xf
    v_mov_b32_dpp v82, v82 row_shl:4 row_mask:0xf bank_mask:0x5
    v_mov_b32_dpp v72, v72 row_shr:4 row_mask:0xf bank_mask:0xa
    v_mov_b32_dpp v73, v73 row_shr:4 row_mask:0xf bank_mask:0xa
    v_mov_b32_dpp v74, v74 row_shr:4 row_mask:0xf bank_mask:0xa
    v_mov_b32_dpp v75, v75 row_shr:4 row_mask:0xf bank_mask:0xa
    v_mul_f32 v72, v72, v82
    v_mul_f32 v73, v73, v82
    v_mul_f32 v74, v74, v82
    v_mul_f32 v75, v75, v82
    v_cvt_pk_bf16_f32 v72, v72, v72
    v_cvt_pk_bf16_f32 v73, v73, v73
    v_cvt_pk_bf16_f32 v74, v74, v74
    v_cvt_pk_bf16_f32 v75, v75, v75
    v_and_b32 v140, v72, v136
    v_and_b32 v141, v72, v137
    v_and_b32 v142, v72, v138
    v_and_b32 v143, v72, v139
    v_and_b32 v144, v73, v136
    v_and_b32 v145, v73, v137
    v_and_b32 v146, v73, v138
    v_and_b32 v147, v73, v139
    v_mfma_f32_16x16x32_bf16 v[152:155], v[140:143], v[8:11], 0
    v_and_b32 v140, v74, v136
    v_and_b32 v141, v74, v137
    v_and_b32 v142, v74, v138
    v_and_b32 v143, v74, v139
    v_mfma_f32_16x16x32_bf16 v[152:155], v[144:147], v[12:15], v[152:155]
    v_and_b32 v144, v75, v136
    v_and_b32 v145, v75, v137
    v_and_b32 v146, v75, v138
    v_and_b32 v147, v75, v139
    v_mfma_f32_16x16x32_bf16 v[152:155], v[140:143], v[16:19], v[152:155]
    s_nop 0
    v_mfma_f32_16x16x32_bf16 v[152:155], v[144:147], v[20:23], v[152:155]
    s_nop 7
    ds_write_b128 v43, v[152:155] offset:15360
    s_waitcnt lgkmcnt(0)
    s_barrier
    s_cmp_lg_u32 s3, 0
    s_cbranch_scc1 L_S_w_14
    ds_read_b128 v[104:107], v42 offset:15360
    ds_read_b128 v[108:111], v42 offset:16384
    ds_read_b128 v[112:115], v42 offset:17408
    ds_read_b128 v[116:119], v42 offset:18432
    ds_read_b128 v[120:123], v42 offset:19456
    ds_read_b128 v[124:127], v42 offset:20480
    ds_read_b128 v[128:131], v42 offset:21504
    ds_read_b128 v[132:135], v42 offset:22528
    s_waitcnt lgkmcnt(6)
    v_pk_add_f32 v[104:105], v[104:105], v[108:109]
    v_pk_add_f32 v[106:107], v[106:107], v[110:111]
    s_waitcnt lgkmcnt(4)
    v_pk_add_f32 v[112:113], v[112:113], v[116:117]
    v_pk_add_f32 v[114:115], v[114:115], v[118:119]
    s_waitcnt lgkmcnt(2)
    v_pk_add_f32 v[120:121], v[120:121], v[124:125]
    v_pk_add_f32 v[122:123], v[122:123], v[126:127]
    v_pk_add_f32 v[104:105], v[104:105], v[112:113]
    v_pk_add_f32 v[106:107], v[106:107], v[114:115]
    s_waitcnt lgkmcnt(0)
    v_pk_add_f32 v[128:129], v[128:129], v[132:133]
    v_pk_add_f32 v[130:131], v[130:131], v[134:135]
    v_pk_add_f32 v[120:121], v[120:121], v[128:129]
    v_pk_add_f32 v[122:123], v[122:123], v[130:131]
    v_pk_add_f32 v[104:105], v[104:105], v[120:121]
    v_pk_add_f32 v[106:107], v[106:107], v[122:123]
    v_add_u32 v104, 0x800, v104
    v_add_u32 v105, 0x800, v105
    v_add_u32 v106, 0x800, v106
    v_add_u32 v107, 0x800, v107
    v_and_or_b32 v104, v104, s60, v164
    v_and_or_b32 v105, v105, s60, v164
    v_and_or_b32 v106, v106, s60, v164
    v_and_or_b32 v107, v107, s60, v164
    buffer_store_dwordx4 v[104:107], v42, s[48:51], s69 offen sc1
L_S_w_14:
    s_endpgm
L_o2_glob_5:
    buffer_store_dword v72, v149, s[48:51], s101 offen sc1
    s_branch L_o2_done_6
L_red_9:
    s_waitcnt vmcnt(1)
    s_nop 2
    s_cmp_eq_u32 s3, 0
    s_cbranch_scc1 L_R_w0_16
    s_sub_u32 s57, s3, 3
    s_cmp_gt_u32 s57, 1
    s_cbranch_scc1 L_R_end_15
    s_sub_u32 s57, s5, 5
    s_lshl_b32 s57, s57, 5
    s_add_u32 s57, s57, s4
    s_cmp_ge_u32 s57, 80
    s_cbranch_scc1 L_R_end_15
    s_lshr_b32 s62, s57, 4
    s_bfe_u32 s63, s57, 0x10003
    s_and_b32 s64, s57, 7
    v_and_b32 v7, 3, v1
    v_lshrrev_b32 v6, 2, v1
    v_lshlrev_b32 v5, 10, v6
    v_lshl_add_u32 v5, v7, 4, v5
    s_lshl_b32 s66, s63, 9
    s_lshl_b32 s67, s64, 6
    s_add_u32 s66, s66, s67
    s_lshl_b32 s67, s62, 15
    s_add_u32 s66, s66, s67
    s_cmp_eq_u32 s3, 3
    s_cbranch_scc1 L_R_S_17
    v_cmp_gt_u32 vcc, 11, v6
    v_add_u32 v10, 0x4000, v5
    s_nop 0
    v_cndmask_b32 v10, v5, v10, vcc
    v_cndmask_b32 v11, 0, 1.0, vcc
    s_add_u32 s67, s66, 0x100000
    s_mov_b32 s58, 400000
    s_mov_b64 s[68:69], -1
    s_mov_b64 s[82:83], s[68:69]
    s_mov_b64 exec, s[68:69]
    buffer_load_dwordx4 v[88:91], v5, s[48:51], s67 offen sc1
    buffer_load_dwordx4 v[92:95], v10, s[48:51], s67 offen sc1
    s_sleep 2
    s_nop 2
L_mp_f_19:
    s_mov_b64 s[84:85], s[68:69]
    s_mov_b64 exec, s[68:69]
    buffer_load_dwordx4 v[96:99], v5, s[48:51], s67 offen sc1
    buffer_load_dwordx4 v[100:103], v10, s[48:51], s67 offen sc1
    s_waitcnt vmcnt(2)
    s_mov_b64 exec, s[82:83]
    v_xor_b32 v88, v88, v164
    v_xor_b32 v89, v89, v164
    v_xor_b32 v90, v90, v164
    v_xor_b32 v91, v91, v164
    v_xor_b32 v92, v92, v164
    v_xor_b32 v93, v93, v164
    v_xor_b32 v94, v94, v164
    v_xor_b32 v95, v95, v164
    v_or3_b32 v12, v88, v89, v90
    v_or3_b32 v12, v12, v91, v92
    v_or3_b32 v12, v12, v93, v94
    v_or_b32 v12, v12, v95
    v_and_b32 v12, 0xfff, v12
    v_cmp_eq_u32 vcc, 0, v12
    s_nop 0
    s_and_b64 exec, exec, vcc
    v_mov_b32 v72, v88
    v_mov_b32 v73, v89
    v_mov_b32 v74, v90
    v_mov_b32 v75, v91
    v_mov_b32 v76, v92
    v_mov_b32 v77, v93
    v_mov_b32 v78, v94
    v_mov_b32 v79, v95
    s_andn2_b64 s[68:69], s[68:69], vcc
    s_cbranch_scc0 L_mp_done_f_18
    s_sub_u32 s58, s58, 1
    s_cbranch_scc1 L_mp_done_f_18
    s_bcnt1_i32_b64 s59, s[68:69]
    s_cmp_le_u32 s59, 32
    s_cbranch_scc1 L_mp_fast_20
    s_sleep 8
L_mp_fast_20:
    s_mov_b64 s[82:83], s[68:69]
    s_mov_b64 exec, s[68:69]
    buffer_load_dwordx4 v[88:91], v5, s[48:51], s67 offen sc1
    buffer_load_dwordx4 v[92:95], v10, s[48:51], s67 offen sc1
    s_waitcnt vmcnt(2)
    s_mov_b64 exec, s[84:85]
    v_xor_b32 v96, v96, v164
    v_xor_b32 v97, v97, v164
    v_xor_b32 v98, v98, v164
    v_xor_b32 v99, v99, v164
    v_xor_b32 v100, v100, v164
    v_xor_b32 v101, v101, v164
    v_xor_b32 v102, v102, v164
    v_xor_b32 v103, v103, v164
    v_or3_b32 v12, v96, v97, v98
    v_or3_b32 v12, v12, v99, v100
    v_or3_b32 v12, v12, v101, v102
    v_or_b32 v12, v12, v103
    v_and_b32 v12, 0xfff, v12
    v_cmp_eq_u32 vcc, 0, v12
    s_nop 0
    s_and_b64 exec, exec, vcc
    v_mov_b32 v72, v96
    v_mov_b32 v73, v97
    v_mov_b32 v74, v98
    v_mov_b32 v75, v99
    v_mov_b32 v76, v100
    v_mov_b32 v77, v101
    v_mov_b32 v78, v102
    v_mov_b32 v79, v103
    s_andn2_b64 s[68:69], s[68:69], vcc
    s_cbranch_scc0 L_mp_done_f_18
    s_sub_u32 s58, s58, 1
    s_cbranch_scc1 L_mp_done_f_18
    s_bcnt1_i32_b64 s59, s[68:69]
    s_cmp_le_u32 s59, 32
    s_cbranch_scc1 L_mp_fast_21
    s_sleep 8
L_mp_fast_21:
    s_branch L_mp_f_19
L_mp_done_f_18:
    s_mov_b64 exec, -1
    s_nop 1
    v_fma_f32 v72, v76, v11, v72
    v_fma_f32 v73, v77, v11, v73
    v_fma_f32 v74, v78, v11, v74
    v_fma_f32 v75, v79, v11, v75
    v_permlane16_swap_b32 v72, v73
    s_nop 0
    v_permlane16_swap_b32 v74, v75
    v_add_f32 v72, v72, v73
    v_add_f32 v74, v74, v75
    s_nop 1
    v_permlane32_swap_b32 v72, v74
    v_add_f32 v72, v72, v74
    s_nop 1
    v_add_f32_dpp v72, v72, v72 row_ror:4 row_mask:0xf bank_mask:0xf
    s_nop 1
    v_add_f32_dpp v72, v72, v72 row_ror:8 row_mask:0xf bank_mask:0xf
    v_cvt_pk_bf16_f32 v72, v72, v72
    v_and_b32 v72, 0xffff0000, v72
    v_mul_f32 v13, 0xbfb8aa3b, v72
    v_exp_f32 v13, v13
    s_nop 0
    v_add_f32 v13, 1.0, v13
    v_rcp_f32 v13, v13
    s_nop 0
    v_mul_f32 v13, v13, v72
    v_cvt_pk_bf16_f32 v13, v13, v13
    v_and_b32 v13, 0xffff0000, v13
    v_lshlrev_b32 v6, 2, v1
    ds_write_b32 v6, v13 offset:39936
    v_mov_b32 v6, 10496
    v_mov_b32 v7, 1
    s_waitcnt lgkmcnt(0)
    ds_write_b32 v6, v7 offset:20
    s_branch L_R_end_15
L_R_S_17:
    s_nop 2
    s_mul_i32 s65, s63, 1280
    s_lshl_b32 s61, s62, 8
    s_add_u32 s65, s65, s61
    s_lshl_b32 s61, s64, 5
    s_add_u32 s65, s65, s61
    v_lshlrev_b32 v4, 3, v7
    v_lshl_add_u32 v4, v3, 1, v4
    s_mov_b32 s40, s16
    s_and_b32 s41, s17, 0xffff
    s_mov_b32 s42, 0xa00
    s_mov_b32 s43, 0x20000
    s_mov_b32 s44, s34
    s_and_b32 s45, s35, 0xffff
    s_mov_b32 s46, 0xa00
    s_mov_b32 s47, 0x20000
    buffer_load_ushort v8, v4, s[40:43], s65 offen
    buffer_load_ushort v9, v4, s[44:47], s65 offen
    v_add_u32 v10, 0x4000, v5
    v_mov_b32 v14, 10496
    v_lshlrev_b32 v15, 2, v1
    s_add_u32 s67, s66, 0xd0000
    s_mov_b32 s58, 400000
    s_mov_b64 s[68:69], -1
    s_mov_b64 s[82:83], s[68:69]
    s_mov_b64 exec, s[68:69]
    buffer_load_dwordx4 v[88:91], v5, s[48:51], s67 offen sc1
    buffer_load_dwordx4 v[92:95], v10, s[48:51], s67 offen sc1
    s_sleep 2
    s_nop 2
L_mp_s_23:
    s_mov_b64 s[84:85], s[68:69]
    s_mov_b64 exec, s[68:69]
    buffer_load_dwordx4 v[96:99], v5, s[48:51], s67 offen sc1
    buffer_load_dwordx4 v[100:103], v10, s[48:51], s67 offen sc1
    s_waitcnt vmcnt(2)
    s_mov_b64 exec, s[82:83]
    v_xor_b32 v88, v88, v164
    v_xor_b32 v89, v89, v164
    v_xor_b32 v90, v90, v164
    v_xor_b32 v91, v91, v164
    v_xor_b32 v92, v92, v164
    v_xor_b32 v93, v93, v164
    v_xor_b32 v94, v94, v164
    v_xor_b32 v95, v95, v164
    v_or3_b32 v12, v88, v89, v90
    v_or3_b32 v12, v12, v91, v92
    v_or3_b32 v12, v12, v93, v94
    v_or_b32 v12, v12, v95
    v_and_b32 v12, 0xfff, v12
    v_cmp_eq_u32 vcc, 0, v12
    s_nop 0
    s_and_b64 exec, exec, vcc
    v_mov_b32 v72, v88
    v_mov_b32 v73, v89
    v_mov_b32 v74, v90
    v_mov_b32 v75, v91
    v_mov_b32 v76, v92
    v_mov_b32 v77, v93
    v_mov_b32 v78, v94
    v_mov_b32 v79, v95
    s_andn2_b64 s[68:69], s[68:69], vcc
    s_cbranch_scc0 L_mp_done_s_22
    s_sub_u32 s58, s58, 1
    s_cbranch_scc1 L_mp_done_s_22
    s_bcnt1_i32_b64 s59, s[68:69]
    s_cmp_le_u32 s59, 32
    s_cbranch_scc1 L_mp_fast_24
    s_sleep 8
L_mp_fast_24:
    s_mov_b64 s[82:83], s[68:69]
    s_mov_b64 exec, s[68:69]
    buffer_load_dwordx4 v[88:91], v5, s[48:51], s67 offen sc1
    buffer_load_dwordx4 v[92:95], v10, s[48:51], s67 offen sc1
    s_waitcnt vmcnt(2)
    s_mov_b64 exec, s[84:85]
    v_xor_b32 v96, v96, v164
    v_xor_b32 v97, v97, v164
    v_xor_b32 v98, v98, v164
    v_xor_b32 v99, v99, v164
    v_xor_b32 v100, v100, v164
    v_xor_b32 v101, v101, v164
    v_xor_b32 v102, v102, v164
    v_xor_b32 v103, v103, v164
    v_or3_b32 v12, v96, v97, v98
    v_or3_b32 v12, v12, v99, v100
    v_or3_b32 v12, v12, v101, v102
    v_or_b32 v12, v12, v103
    v_and_b32 v12, 0xfff, v12
    v_cmp_eq_u32 vcc, 0, v12
    s_nop 0
    s_and_b64 exec, exec, vcc
    v_mov_b32 v72, v96
    v_mov_b32 v73, v97
    v_mov_b32 v74, v98
    v_mov_b32 v75, v99
    v_mov_b32 v76, v100
    v_mov_b32 v77, v101
    v_mov_b32 v78, v102
    v_mov_b32 v79, v103
    s_andn2_b64 s[68:69], s[68:69], vcc
    s_cbranch_scc0 L_mp_done_s_22
    s_sub_u32 s58, s58, 1
    s_cbranch_scc1 L_mp_done_s_22
    s_bcnt1_i32_b64 s59, s[68:69]
    s_cmp_le_u32 s59, 32
    s_cbranch_scc1 L_mp_fast_25
    s_sleep 8
L_mp_fast_25:
    s_branch L_mp_s_23
L_mp_done_s_22:
    s_mov_b64 exec, -1
    s_nop 1
    ds_read_b32 v11, v14 offset:20
    ds_read_b32 v13, v15 offset:39936
    v_add_f32 v72, v72, v76
    v_add_f32 v73, v73, v77
    v_add_f32 v74, v74, v78
    v_add_f32 v75, v75, v79
    v_permlane16_swap_b32 v72, v73
    s_nop 0
    v_permlane16_swap_b32 v74, v75
    v_add_f32 v72, v72, v73
    v_add_f32 v74, v74, v75
    s_nop 1
    v_permlane32_swap_b32 v72, v74
    v_add_f32 v72, v72, v74
    s_nop 1
    v_add_f32_dpp v72, v72, v72 row_ror:4 row_mask:0xf bank_mask:0xf
    s_nop 1
    v_add_f32_dpp v72, v72, v72 row_ror:8 row_mask:0xf bank_mask:0xf
    v_cvt_pk_bf16_f32 v72, v72, v72
    v_and_b32 v72, 0xffff0000, v72
    s_waitcnt lgkmcnt(0)
    v_cmp_eq_u32 vcc, 1, v11
    s_mov_b32 s58, 3200000
    s_cbranch_vccnz L_gok_27
L_gw_26:
    ds_read_b32 v11, v14 offset:20
    ds_read_b32 v13, v15 offset:39936
    s_waitcnt lgkmcnt(0)
    v_cmp_eq_u32 vcc, 1, v11
    s_nop 1
    s_cbranch_vccnz L_gok_27
    s_sub_u32 s58, s58, 1
    s_cbranch_scc0 L_gw_26
L_gok_27:
    s_nop 1
    v_lshlrev_b32 v8, 16, v8
    v_mul_f32 v72, v72, v13
    v_cvt_pk_bf16_f32 v72, v72, v72
    v_and_b32 v72, 0xffff0000, v72
    v_add_f32 v72, v72, v8
    v_cvt_pk_bf16_f32 v72, v72, v72
    s_mov_b32 s62, 0x000f000f
    s_mov_b32 s63, 0x000f000f
    s_mov_b64 exec, s[62:63]
    buffer_store_short v72, v4, s[44:47], s65 offen
    s_cmp_lg_u32 s57, 0
    s_cbranch_scc1 L_nobump_28
    s_mov_b64 exec, 1
    v_add_u32 v6, 1, v165
    v_mov_b32 v7, 0
    buffer_store_dword v6, v7, s[48:51], 0 offen sc1
L_nobump_28:
    s_mov_b64 exec, -1
L_R_end_15:
    s_endpgm
L_R_w0_16:
    s_endpgm
L_A_post:
    s_nop 1
    v_and_b32 v166, 1, v1
    v_cmp_eq_u32 vcc, 1, v166
    v_mov_b32 v166, 0xffff
    v_mov_b32 v167, 0xffff0000
    v_cndmask_b32 v166, v166, v167, vcc
    v_bfe_u32 v167, v1, 1, 2
    v_cmp_eq_u32 vcc, 0, v167
    s_nop 1
    v_cndmask_b32 v148, 0, v166, vcc
    v_cmp_eq_u32 vcc, 1, v167
    s_nop 1
    v_cndmask_b32 v149, 0, v166, vcc
    v_cmp_eq_u32 vcc, 2, v167
    s_nop 1
    v_cndmask_b32 v150, 0, v166, vcc
    v_cmp_eq_u32 vcc, 3, v167
    s_nop 1
    v_cndmask_b32 v151, 0, v166, vcc
    s_waitcnt vmcnt(21)
    v_lshlrev_b32 v16, 16, v4
    v_and_b32 v17, 0xffff0000, v4
    v_lshlrev_b32 v18, 16, v5
    v_and_b32 v19, 0xffff0000, v5
    v_lshlrev_b32 v20, 16, v6
    v_and_b32 v21, 0xffff0000, v6
    v_lshlrev_b32 v22, 16, v7
    v_and_b32 v23, 0xffff0000, v7
    v_lshlrev_b32 v24, 16, v8
    v_and_b32 v25, 0xffff0000, v8
    v_lshlrev_b32 v26, 16, v9
    v_and_b32 v27, 0xffff0000, v9
    v_lshlrev_b32 v28, 16, v10
    v_and_b32 v29, 0xffff0000, v10
    v_lshlrev_b32 v30, 16, v11
    v_and_b32 v31, 0xffff0000, v11
    v_lshlrev_b32 v32, 16, v12
    v_and_b32 v33, 0xffff0000, v12
    v_lshlrev_b32 v34, 16, v13
    v_and_b32 v35, 0xffff0000, v13
    v_pk_add_f32 v[36:37], v[16:17], v[18:19]
    v_pk_add_f32 v[38:39], v[20:21], v[22:23]
    v_pk_add_f32 v[40:41], v[24:25], v[26:27]
    v_pk_add_f32 v[42:43], v[28:29], v[30:31]
    v_pk_add_f32 v[44:45], v[32:33], v[34:35]
    v_pk_add_f32 v[36:37], v[36:37], v[38:39]
    v_pk_add_f32 v[40:41], v[40:41], v[42:43]
    v_pk_add_f32 v[36:37], v[36:37], v[44:45]
    v_pk_add_f32 v[36:37], v[36:37], v[40:41]
    v_add_f32 v46, v36, v37
    s_nop 1
    v_add_f32_dpp v46, v46, v46 quad_perm:[1,0,3,2] row_mask:0xf bank_mask:0xf
    s_nop 1
    v_add_f32_dpp v46, v46, v46 quad_perm:[2,3,0,1] row_mask:0xf bank_mask:0xf
    s_nop 1
    v_add_f32_dpp v46, v46, v46 row_half_mirror row_mask:0xf bank_mask:0xf
    s_nop 1
    v_add_f32_dpp v46, v46, v46 row_mirror row_mask:0xf bank_mask:0xf
    v_mov_b32 v47, v46
    s_nop 1
    v_permlane16_swap_b32 v46, v47
    v_add_f32 v46, v46, v47
    v_mul_f32 v44, 0x3acccccd, v46
    v_sub_f32 v42, 0, v44
    v_sub_f32 v43, 0, v44
    v_mov_b32 v40, 0
    v_mov_b32 v41, 0
    v_pk_add_f32 v[36:37], v[16:17], v[42:43]
    v_pk_fma_f32 v[40:41], v[36:37], v[36:37], v[40:41]
    v_pk_add_f32 v[38:39], v[18:19], v[42:43]
    v_pk_fma_f32 v[40:41], v[38:39], v[38:39], v[40:41]
    v_pk_add_f32 v[36:37], v[20:21], v[42:43]
    v_pk_fma_f32 v[40:41], v[36:37], v[36:37], v[40:41]
    v_pk_add_f32 v[38:39], v[22:23], v[42:43]
    v_pk_fma_f32 v[40:41], v[38:39], v[38:39], v[40:41]
    v_pk_add_f32 v[36:37], v[24:25], v[42:43]
    v_pk_fma_f32 v[40:41], v[36:37], v[36:37], v[40:41]
    v_pk_add_f32 v[38:39], v[26:27], v[42:43]
    v_pk_fma_f32 v[40:41], v[38:39], v[38:39], v[40:41]
    v_pk_add_f32 v[36:37], v[28:29], v[42:43]
    v_pk_fma_f32 v[40:41], v[36:37], v[36:37], v[40:41]
    v_pk_add_f32 v[38:39], v[30:31], v[42:43]
    v_pk_fma_f32 v[40:41], v[38:39], v[38:39], v[40:41]
    v_pk_add_f32 v[36:37], v[32:33], v[42:43]
    v_pk_fma_f32 v[40:41], v[36:37], v[36:37], v[40:41]
    v_pk_add_f32 v[38:39], v[34:35], v[42:43]
    v_pk_fma_f32 v[40:41], v[38:39], v[38:39], v[40:41]
    v_add_f32 v46, v40, v41
    s_nop 1
    v_add_f32_dpp v46, v46, v46 quad_perm:[1,0,3,2] row_mask:0xf bank_mask:0xf
    s_nop 1
    v_add_f32_dpp v46, v46, v46 quad_perm:[2,3,0,1] row_mask:0xf bank_mask:0xf
    s_nop 1
    v_add_f32_dpp v46, v46, v46 row_half_mirror row_mask:0xf bank_mask:0xf
    s_nop 1
    v_add_f32_dpp v46, v46, v46 row_mirror row_mask:0xf bank_mask:0xf
    v_mov_b32 v47, v46
    s_nop 1
    v_permlane16_swap_b32 v46, v47
    v_add_f32 v46, v46, v47
    v_mul_f32 v46, 0x3acccccd, v46
    v_cvt_pk_bf16_f32 v47, v44, v46
    v_lshlrev_b32 v44, 16, v47
    v_and_b32 v46, 0xffff0000, v47
    v_add_f32 v46, 0x3727c5ac, v46
    v_cvt_pk_bf16_f32 v46, v46, v46
    v_and_b32 v46, 0xffff0000, v46
    v_sqrt_f32 v46, v46
    s_nop 0
    v_cvt_pk_bf16_f32 v46, v46, v46
    v_and_b32 v46, 0xffff0000, v46
    v_rcp_f32 v40, v46
    v_sub_f32 v42, 0, v44
    v_sub_f32 v43, 0, v44
    v_mov_b32 v41, v40
    v_pk_add_f32 v[36:37], v[16:17], v[42:43]
    v_cvt_pk_bf16_f32 v46, v36, v37
    v_lshlrev_b32 v36, 16, v46
    v_and_b32 v37, 0xffff0000, v46
    v_pk_mul_f32 v[36:37], v[36:37], v[40:41]
    v_cvt_pk_bf16_f32 v16, v36, v36
    v_cvt_pk_bf16_f32 v17, v37, v37
    v_pk_add_f32 v[38:39], v[18:19], v[42:43]
    v_cvt_pk_bf16_f32 v46, v38, v39
    v_lshlrev_b32 v38, 16, v46
    v_and_b32 v39, 0xffff0000, v46
    v_pk_mul_f32 v[38:39], v[38:39], v[40:41]
    v_cvt_pk_bf16_f32 v18, v38, v38
    v_cvt_pk_bf16_f32 v19, v39, v39
    v_pk_add_f32 v[36:37], v[20:21], v[42:43]
    v_cvt_pk_bf16_f32 v46, v36, v37
    v_lshlrev_b32 v36, 16, v46
    v_and_b32 v37, 0xffff0000, v46
    v_pk_mul_f32 v[36:37], v[36:37], v[40:41]
    v_cvt_pk_bf16_f32 v20, v36, v36
    v_cvt_pk_bf16_f32 v21, v37, v37
    v_pk_add_f32 v[38:39], v[22:23], v[42:43]
    v_cvt_pk_bf16_f32 v46, v38, v39
    v_lshlrev_b32 v38, 16, v46
    v_and_b32 v39, 0xffff0000, v46
    v_pk_mul_f32 v[38:39], v[38:39], v[40:41]
    v_cvt_pk_bf16_f32 v22, v38, v38
    v_cvt_pk_bf16_f32 v23, v39, v39
    v_pk_add_f32 v[36:37], v[24:25], v[42:43]
    v_cvt_pk_bf16_f32 v46, v36, v37
    v_lshlrev_b32 v36, 16, v46
    v_and_b32 v37, 0xffff0000, v46
    v_pk_mul_f32 v[36:37], v[36:37], v[40:41]
    v_cvt_pk_bf16_f32 v24, v36, v36
    v_cvt_pk_bf16_f32 v25, v37, v37
    v_pk_add_f32 v[38:39], v[26:27], v[42:43]
    v_cvt_pk_bf16_f32 v46, v38, v39
    v_lshlrev_b32 v38, 16, v46
    v_and_b32 v39, 0xffff0000, v46
    v_pk_mul_f32 v[38:39], v[38:39], v[40:41]
    v_cvt_pk_bf16_f32 v26, v38, v38
    v_cvt_pk_bf16_f32 v27, v39, v39
    v_pk_add_f32 v[36:37], v[28:29], v[42:43]
    v_cvt_pk_bf16_f32 v46, v36, v37
    v_lshlrev_b32 v36, 16, v46
    v_and_b32 v37, 0xffff0000, v46
    v_pk_mul_f32 v[36:37], v[36:37], v[40:41]
    v_cvt_pk_bf16_f32 v28, v36, v36
    v_cvt_pk_bf16_f32 v29, v37, v37
    v_pk_add_f32 v[38:39], v[30:31], v[42:43]
    v_cvt_pk_bf16_f32 v46, v38, v39
    v_lshlrev_b32 v38, 16, v46
    v_and_b32 v39, 0xffff0000, v46
    v_pk_mul_f32 v[38:39], v[38:39], v[40:41]
    v_cvt_pk_bf16_f32 v30, v38, v38
    v_cvt_pk_bf16_f32 v31, v39, v39
    v_pk_add_f32 v[36:37], v[32:33], v[42:43]
    v_cvt_pk_bf16_f32 v46, v36, v37
    v_lshlrev_b32 v36, 16, v46
    v_and_b32 v37, 0xffff0000, v46
    v_pk_mul_f32 v[36:37], v[36:37], v[40:41]
    v_cvt_pk_bf16_f32 v32, v36, v36
    v_cvt_pk_bf16_f32 v33, v37, v37
    v_pk_add_f32 v[38:39], v[34:35], v[42:43]
    v_cvt_pk_bf16_f32 v46, v38, v39
    v_lshlrev_b32 v38, 16, v46
    v_and_b32 v39, 0xffff0000, v46
    v_pk_mul_f32 v[38:39], v[38:39], v[40:41]
    v_cvt_pk_bf16_f32 v34, v38, v38
    v_cvt_pk_bf16_f32 v35, v39, v39
    v_mul_u32_u24 v46, 80, v1
    v_add_u32 v46, s59, v46
    ds_write_b128 v46, v[16:19] offset:0
    ds_write_b128 v46, v[20:23] offset:16
    ds_write_b128 v46, v[24:27] offset:32
    ds_write_b128 v46, v[28:31] offset:48
    ds_write_b128 v46, v[32:35] offset:64
    v_bfe_u32 v46, v1, 3, 1
    v_mul_u32_u24 v46, 2560, v46
    v_lshrrev_b32 v47, 4, v1
    v_lshlrev_b32 v47, 2, v47
    s_mul_i32 s60, s5, 320
    s_add_u32 s60, s60, s59
    v_add3_u32 v46, v46, v47, s60
    s_waitcnt lgkmcnt(0)
    ds_read2_b32 v[128:129], v46 offset0:0 offset1:4
    ds_read2_b32 v[130:131], v46 offset0:8 offset1:12
    ds_read2_b32 v[132:133], v46 offset0:16 offset1:20
    ds_read2_b32 v[134:135], v46 offset0:24 offset1:28
    ds_read2_b32 v[136:137], v46 offset0:32 offset1:36
    ds_read2_b32 v[138:139], v46 offset0:40 offset1:44
    ds_read2_b32 v[140:141], v46 offset0:48 offset1:52
    ds_read2_b32 v[142:143], v46 offset0:56 offset1:60
    ds_read2_b32 v[144:145], v46 offset0:64 offset1:68
    ds_read2_b32 v[146:147], v46 offset0:72 offset1:76
    s_waitcnt lgkmcnt(0)
    v_and_b32 v152, v128, v148
    v_and_b32 v153, v128, v149
    v_and_b32 v154, v128, v150
    v_and_b32 v155, v128, v151
    v_and_b32 v156, v129, v148
    v_and_b32 v157, v129, v149
    v_and_b32 v158, v129, v150
    v_and_b32 v159, v129, v151
    s_waitcnt vmcnt(19)
    v_mfma_f32_16x16x32_bf16 v[160:163], v[152:155], v[48:51], 0
    v_and_b32 v152, v130, v148
    v_and_b32 v153, v130, v149
    v_and_b32 v154, v130, v150
    v_and_b32 v155, v130, v151
    s_waitcnt vmcnt(18)
    v_mfma_f32_16x16x32_bf16 v[160:163], v[156:159], v[52:55], v[160:163]
    v_and_b32 v156, v131, v148
    v_and_b32 v157, v131, v149
    v_and_b32 v158, v131, v150
    v_and_b32 v159, v131, v151
    s_waitcnt vmcnt(17)
    v_mfma_f32_16x16x32_bf16 v[160:163], v[152:155], v[56:59], v[160:163]
    v_and_b32 v152, v132, v148
    v_and_b32 v153, v132, v149
    v_and_b32 v154, v132, v150
    v_and_b32 v155, v132, v151
    s_waitcnt vmcnt(16)
    v_mfma_f32_16x16x32_bf16 v[160:163], v[156:159], v[60:63], v[160:163]
    v_and_b32 v156, v133, v148
    v_and_b32 v157, v133, v149
    v_and_b32 v158, v133, v150
    v_and_b32 v159, v133, v151
    s_waitcnt vmcnt(15)
    v_mfma_f32_16x16x32_bf16 v[160:163], v[152:155], v[64:67], v[160:163]
    v_and_b32 v152, v134, v148
    v_and_b32 v153, v134, v149
    v_and_b32 v154, v134, v150
    v_and_b32 v155, v134, v151
    s_waitcnt vmcnt(14)
    v_mfma_f32_16x16x32_bf16 v[160:163], v[156:159], v[68:71], v[160:163]
    v_and_b32 v156, v135, v148
    v_and_b32 v157, v135, v149
    v_and_b32 v158, v135, v150
    v_and_b32 v159, v135, v151
    s_waitcnt vmcnt(13)
    v_mfma_f32_16x16x32_bf16 v[160:163], v[152:155], v[72:75], v[160:163]
    v_and_b32 v152, v136, v148
    v_and_b32 v153, v136, v149
    v_and_b32 v154, v136, v150
    v_and_b32 v155, v136, v151
    s_waitcnt vmcnt(12)
    v_mfma_f32_16x16x32_bf16 v[160:163], v[156:159], v[76:79], v[160:163]
    v_and_b32 v156, v137, v148
    v_and_b32 v157, v137, v149
    v_and_b32 v158, v137, v150
    v_and_b32 v159, v137, v151
    s_waitcnt vmcnt(11)
    v_mfma_f32_16x16x32_bf16 v[160:163], v[152:155], v[80:83], v[160:163]
    v_and_b32 v152, v138, v148
    v_and_b32 v153, v138, v149
    v_and_b32 v154, v138, v150
    v_and_b32 v155, v138, v151
    s_waitcnt vmcnt(10)
    v_mfma_f32_16x16x32_bf16 v[160:163], v[156:159], v[84:87], v[160:163]
    v_and_b32 v156, v139, v148
    v_and_b32 v157, v139, v149
    v_and_b32 v158, v139, v150
    v_and_b32 v159, v139, v151
    s_waitcnt vmcnt(9)
    v_mfma_f32_16x16x32_bf16 v[160:163], v[152:155], v[88:91], v[160:163]
    v_and_b32 v152, v140, v148
    v_and_b32 v153, v140, v149
    v_and_b32 v154, v140, v150
    v_and_b32 v155, v140, v151
    s_waitcnt vmcnt(8)
    v_mfma_f32_16x16x32_bf16 v[160:163], v[156:159], v[92:95], v[160:163]
    v_and_b32 v156, v141, v148
    v_and_b32 v157, v141, v149
    v_and_b32 v158, v141, v150
    v_and_b32 v159, v141, v151
    s_waitcnt vmcnt(7)
    v_mfma_f32_16x16x32_bf16 v[160:163], v[152:155], v[96:99], v[160:163]
    v_and_b32 v152, v142, v148
    v_and_b32 v153, v142, v149
    v_and_b32 v154, v142, v150
    v_and_b32 v155, v142, v151
    s_waitcnt vmcnt(6)
    v_mfma_f32_16x16x32_bf16 v[160:163], v[156:159], v[100:103], v[160:163]
    v_and_b32 v156, v143, v148
    v_and_b32 v157, v143, v149
    v_and_b32 v158, v143, v150
    v_and_b32 v159, v143, v151
    s_waitcnt vmcnt(5)
    v_mfma_f32_16x16x32_bf16 v[160:163], v[152:155], v[104:107], v[160:163]
    v_and_b32 v152, v144, v148
    v_and_b32 v153, v144, v149
    v_and_b32 v154, v144, v150
    v_and_b32 v155, v144, v151
    s_waitcnt vmcnt(4)
    v_mfma_f32_16x16x32_bf16 v[160:163], v[156:159], v[108:111], v[160:163]
    v_and_b32 v156, v145, v148
    v_and_b32 v157, v145, v149
    v_and_b32 v158, v145, v150
    v_and_b32 v159, v145, v151
    s_waitcnt vmcnt(3)
    v_mfma_f32_16x16x32_bf16 v[160:163], v[152:155], v[112:115], v[160:163]
    v_and_b32 v152, v146, v148
    v_and_b32 v153, v146, v149
    v_and_b32 v154, v146, v150
    v_and_b32 v155, v146, v151
    s_waitcnt vmcnt(2)
    v_mfma_f32_16x16x32_bf16 v[160:163], v[156:159], v[116:119], v[160:163]
    v_and_b32 v156, v147, v148
    v_and_b32 v157, v147, v149
    v_and_b32 v158, v147, v150
    v_and_b32 v159, v147, v151
    s_waitcnt vmcnt(1)
    v_mfma_f32_16x16x32_bf16 v[160:163], v[152:155], v[120:123], v[160:163]
    s_waitcnt vmcnt(0)
    v_mfma_f32_16x16x32_bf16 v[160:163], v[156:159], v[124:127], v[160:163]
    v_add_u32 v15, 1, v14
    v_and_b32 v15, 0xfff, v15
    s_mov_b32 s54, 0xfffff000
    v_lshrrev_b32 v47, 5, v1
    v_lshlrev_b32 v46, 9, v47
    v_and_b32 v47, 15, v1
    v_lshl_add_u32 v46, v47, 5, v46
    v_and_b32 v47, 16, v1
    v_add_u32 v46, v46, v47
    s_lshl_b32 s55, s9, 3
    s_add_u32 s55, s55, s5
    s_lshl_b32 s55, s55, 10
    s_add_u32 s56, s55, 0x10000
    v_add_u32 v160, 0x800, v160
    v_add_u32 v161, 0x800, v161
    v_add_u32 v162, 0x800, v162
    v_add_u32 v163, 0x800, v163
    v_and_or_b32 v160, v160, s54, v15
    v_and_or_b32 v161, v161, s54, v15
    v_and_or_b32 v162, v162, s54, v15
    v_and_or_b32 v163, v163, s54, v15
    buffer_store_dwordx4 v[160:163], v46, s[48:51], s56 offen sc1
    s_cmp_eq_u32 s3, 2
    s_cbranch_scc1 L_A_end_31
    s_branch L_A_gather_30
L_A_gather_30:
    s_nop 2
    s_lshl_b32 s55, s4, 3
    s_add_u32 s55, s55, s5
    s_lshl_b32 s55, s55, 10
    s_getreg_b32 s61, hwreg(HW_REG_XCC_ID)
    s_and_b32 s61, s61, 15
    s_lshl_b32 s61, s61, 12
    v_or_b32 v68, s61, v15
    v_mov_b32 v69, v68
    v_mov_b32 v70, v68
    v_mov_b32 v71, v68
    s_lshr_b32 s62, s55, 6
    s_add_u32 s62, s62, 0x8000
    v_mov_b32 v72, 0
    s_mov_b64 exec, 1
    buffer_store_dwordx4 v[68:71], v72, s[48:51], s62 offen sc1
    s_mov_b64 exec, -1
    v_and_b32 v72, 7, v1
    v_lshlrev_b32 v72, 4, v72
    s_lshl_b32 s62, s4, 7
    s_add_u32 s62, s62, 0x8000
    v_lshrrev_b32 v46, 5, v1
    v_lshlrev_b32 v46, 10, v46
    v_and_b32 v47, 31, v1
    v_lshl_add_u32 v46, v47, 4, v46
    s_lshl_b32 s56, s4, 13
    s_lshr_b32 s57, s5, 2
    s_lshl_b32 s57, s57, 9
    s_add_u32 s56, s56, s57
    s_add_u32 s56, s56, 0x10000
    s_add_u32 s57, s56, 4096
    s_mov_b32 s58, 400000
    s_sleep 40
    s_nop 3
L_poll_q_35:
    buffer_load_dwordx4 v[48:51], v46, s[48:51], s56 offen sc1
    buffer_load_dwordx4 v[52:55], v46, s[48:51], s56 offen offset:2048 sc1
    buffer_load_dwordx4 v[56:59], v46, s[48:51], s57 offen sc1
    buffer_load_dwordx4 v[60:63], v46, s[48:51], s57 offen offset:2048 sc1
    buffer_load_dwordx4 v[64:67], v72, s[48:51], s62 offen sc1
    s_waitcnt vmcnt(0)
    v_xor_b32 v48, v48, v15
    v_xor_b32 v49, v49, v15
    v_xor_b32 v50, v50, v15
    v_xor_b32 v51, v51, v15
    v_xor_b32 v52, v52, v15
    v_xor_b32 v53, v53, v15
    v_xor_b32 v54, v54, v15
    v_xor_b32 v55, v55, v15
    v_xor_b32 v56, v56, v15
    v_xor_b32 v57, v57, v15
    v_xor_b32 v58, v58, v15
    v_xor_b32 v59, v59, v15
    v_xor_b32 v60, v60, v15
    v_xor_b32 v61, v61, v15
    v_xor_b32 v62, v62, v15
    v_xor_b32 v63, v63, v15
    v_xor_b32 v64, v64, v15
    v_xor_b32 v65, v65, v15
    v_xor_b32 v66, v66, v15
    v_xor_b32 v67, v67, v15
    v_or3_b32 v73, v48, v49, v50
    v_or3_b32 v73, v73, v51, v52
    v_or3_b32 v73, v73, v53, v54
    v_or3_b32 v73, v73, v55, v56
    v_or3_b32 v73, v73, v57, v58
    v_or3_b32 v73, v73, v59, v60
    v_or3_b32 v73, v73, v61, v62
    v_or3_b32 v73, v73, v63, v64
    v_or3_b32 v73, v73, v65, v66
    v_or_b32 v73, v73, v67
    v_and_b32 v73, 0xfff, v73
    v_cmp_ne_u32 vcc, 0, v73
    s_nop 1
    s_cbranch_vccz L_ok_q_36
    s_sub_u32 s58, s58, 1
    s_cbranch_scc1 L_ok_q_36
    s_sleep 8
    s_branch L_poll_q_35
L_ok_q_36:
    s_nop 1
    v_cmp_ne_u32 vcc, s61, v64
    s_nop 1
    s_cmp_eq_u64 vcc, 0
    s_cselect_b32 s63, 1, 0
    v_mov_b32 v74, s63
    ds_write_b32 v164, v74 offset:16
    v_pk_add_f32 v[48:49], v[48:49], v[52:53]
    v_pk_add_f32 v[56:57], v[56:57], v[60:61]
    v_pk_add_f32 v[48:49], v[48:49], v[56:57]
    v_pk_add_f32 v[50:51], v[50:51], v[54:55]
    v_pk_add_f32 v[58:59], v[58:59], v[62:63]
    v_pk_add_f32 v[50:51], v[50:51], v[58:59]
    v_mov_b32 v52, v48
    v_mov_b32 v53, v49
    v_mov_b32 v54, v50
    v_mov_b32 v55, v51
    v_permlane32_swap_b32 v48, v52
    v_permlane32_swap_b32 v49, v53
    v_permlane32_swap_b32 v50, v54
    v_permlane32_swap_b32 v51, v55
    v_add_f32 v48, v48, v52
    v_add_f32 v49, v49, v53
    v_add_f32 v50, v50, v54
    v_add_f32 v51, v51, v55
    v_cvt_pk_bf16_f32 v56, v48, v49
    v_cvt_pk_bf16_f32 v57, v50, v51
    v_lshlrev_b32 v47, 3, v47
    ds_write_b64 v47, v[56:57] offset:10240
    v_mov_b32 v58, v15
    v_mov_b32 v59, v14
    ds_write_b64 v164, v[58:59] offset:4
    s_waitcnt lgkmcnt(0)
    v_mov_b32 v60, 1
    ds_write_b32 v164, v60
    s_waitcnt lgkmcnt(0)
    s_endpgm
L_B_post:
    s_nop 1
    v_and_b32 v164, 1, v1
    v_cmp_eq_u32 vcc, 1, v164
    v_mov_b32 v164, 0xffff
    v_mov_b32 v165, 0xffff0000
    v_cndmask_b32 v164, v164, v165, vcc
    v_bfe_u32 v165, v1, 1, 2
    v_cmp_eq_u32 vcc, 0, v165
    s_nop 1
    v_cndmask_b32 v148, 0, v164, vcc
    v_cmp_eq_u32 vcc, 1, v165
    s_nop 1
    v_cndmask_b32 v149, 0, v164, vcc
    v_cmp_eq_u32 vcc, 2, v165
    s_nop 1
    v_cndmask_b32 v150, 0, v164, vcc
    v_cmp_eq_u32 vcc, 3, v165
    s_nop 1
    v_cndmask_b32 v151, 0, v164, vcc
    s_waitcnt vmcnt(21)
    s_movk_i32 s59, 5120
    v_lshlrev_b32 v16, 16, v4
    v_and_b32 v17, 0xffff0000, v4
    v_lshlrev_b32 v18, 16, v5
    v_and_b32 v19, 0xffff0000, v5
    v_lshlrev_b32 v20, 16, v6
    v_and_b32 v21, 0xffff0000, v6
    v_lshlrev_b32 v22, 16, v7
    v_and_b32 v23, 0xffff0000, v7
    v_lshlrev_b32 v24, 16, v8
    v_and_b32 v25, 0xffff0000, v8
    v_lshlrev_b32 v26, 16, v9
    v_and_b32 v27, 0xffff0000, v9
    v_lshlrev_b32 v28, 16, v10
    v_and_b32 v29, 0xffff0000, v10
    v_lshlrev_b32 v30, 16, v11
    v_and_b32 v31, 0xffff0000, v11
    v_lshlrev_b32 v32, 16, v12
    v_and_b32 v33, 0xffff0000, v12
    v_lshlrev_b32 v34, 16, v13
    v_and_b32 v35, 0xffff0000, v13
    v_pk_add_f32 v[36:37], v[16:17], v[18:19]
    v_pk_add_f32 v[38:39], v[20:21], v[22:23]
    v_pk_add_f32 v[40:41], v[24:25], v[26:27]
    v_pk_add_f32 v[42:43], v[28:29], v[30:31]
    v_pk_add_f32 v[44:45], v[32:33], v[34:35]
    v_pk_add_f32 v[36:37], v[36:37], v[38:39]
    v_pk_add_f32 v[40:41], v[40:41], v[42:43]
    v_pk_add_f32 v[36:37], v[36:37], v[44:45]
    v_pk_add_f32 v[36:37], v[36:37], v[40:41]
    v_add_f32 v46, v36, v37
    s_nop 1
    v_add_f32_dpp v46, v46, v46 quad_perm:[1,0,3,2] row_mask:0xf bank_mask:0xf
    s_nop 1
    v_add_f32_dpp v46, v46, v46 quad_perm:[2,3,0,1] row_mask:0xf bank_mask:0xf
    s_nop 1
    v_add_f32_dpp v46, v46, v46 row_half_mirror row_mask:0xf bank_mask:0xf
    s_nop 1
    v_add_f32_dpp v46, v46, v46 row_mirror row_mask:0xf bank_mask:0xf
    v_mov_b32 v47, v46
    s_nop 1
    v_permlane16_swap_b32 v46, v47
    v_add_f32 v46, v46, v47
    v_mul_f32 v44, 0x3acccccd, v46
    v_sub_f32 v42, 0, v44
    v_sub_f32 v43, 0, v44
    v_mov_b32 v40, 0
    v_mov_b32 v41, 0
    v_pk_add_f32 v[36:37], v[16:17], v[42:43]
    v_pk_fma_f32 v[40:41], v[36:37], v[36:37], v[40:41]
    v_pk_add_f32 v[38:39], v[18:19], v[42:43]
    v_pk_fma_f32 v[40:41], v[38:39], v[38:39], v[40:41]
    v_pk_add_f32 v[36:37], v[20:21], v[42:43]
    v_pk_fma_f32 v[40:41], v[36:37], v[36:37], v[40:41]
    v_pk_add_f32 v[38:39], v[22:23], v[42:43]
    v_pk_fma_f32 v[40:41], v[38:39], v[38:39], v[40:41]
    v_pk_add_f32 v[36:37], v[24:25], v[42:43]
    v_pk_fma_f32 v[40:41], v[36:37], v[36:37], v[40:41]
    v_pk_add_f32 v[38:39], v[26:27], v[42:43]
    v_pk_fma_f32 v[40:41], v[38:39], v[38:39], v[40:41]
    v_pk_add_f32 v[36:37], v[28:29], v[42:43]
    v_pk_fma_f32 v[40:41], v[36:37], v[36:37], v[40:41]
    v_pk_add_f32 v[38:39], v[30:31], v[42:43]
    v_pk_fma_f32 v[40:41], v[38:39], v[38:39], v[40:41]
    v_pk_add_f32 v[36:37], v[32:33], v[42:43]
    v_pk_fma_f32 v[40:41], v[36:37], v[36:37], v[40:41]
    v_pk_add_f32 v[38:39], v[34:35], v[42:43]
    v_pk_fma_f32 v[40:41], v[38:39], v[38:39], v[40:41]
    v_add_f32 v46, v40, v41
    s_nop 1
    v_add_f32_dpp v46, v46, v46 quad_perm:[1,0,3,2] row_mask:0xf bank_mask:0xf
    s_nop 1
    v_add_f32_dpp v46, v46, v46 quad_perm:[2,3,0,1] row_mask:0xf bank_mask:0xf
    s_nop 1
    v_add_f32_dpp v46, v46, v46 row_half_mirror row_mask:0xf bank_mask:0xf
    s_nop 1
    v_add_f32_dpp v46, v46, v46 row_mirror row_mask:0xf bank_mask:0xf
    v_mov_b32 v47, v46
    s_nop 1
    v_permlane16_swap_b32 v46, v47
    v_add_f32 v46, v46, v47
    v_mul_f32 v46, 0x3acccccd, v46
    v_cvt_pk_bf16_f32 v47, v44, v46
    v_lshlrev_b32 v44, 16, v47
    v_and_b32 v46, 0xffff0000, v47
    v_add_f32 v46, 0x3727c5ac, v46
    v_cvt_pk_bf16_f32 v46, v46, v46
    v_and_b32 v46, 0xffff0000, v46
    v_sqrt_f32 v46, v46
    s_nop 0
    v_cvt_pk_bf16_f32 v46, v46, v46
    v_and_b32 v46, 0xffff0000, v46
    v_rcp_f32 v40, v46
    v_sub_f32 v42, 0, v44
    v_sub_f32 v43, 0, v44
    v_mov_b32 v41, v40
    v_pk_add_f32 v[36:37], v[16:17], v[42:43]
    v_cvt_pk_bf16_f32 v46, v36, v37
    v_lshlrev_b32 v36, 16, v46
    v_and_b32 v37, 0xffff0000, v46
    v_pk_mul_f32 v[36:37], v[36:37], v[40:41]
    v_cvt_pk_bf16_f32 v16, v36, v36
    v_cvt_pk_bf16_f32 v17, v37, v37
    v_pk_add_f32 v[38:39], v[18:19], v[42:43]
    v_cvt_pk_bf16_f32 v46, v38, v39
    v_lshlrev_b32 v38, 16, v46
    v_and_b32 v39, 0xffff0000, v46
    v_pk_mul_f32 v[38:39], v[38:39], v[40:41]
    v_cvt_pk_bf16_f32 v18, v38, v38
    v_cvt_pk_bf16_f32 v19, v39, v39
    v_pk_add_f32 v[36:37], v[20:21], v[42:43]
    v_cvt_pk_bf16_f32 v46, v36, v37
    v_lshlrev_b32 v36, 16, v46
    v_and_b32 v37, 0xffff0000, v46
    v_pk_mul_f32 v[36:37], v[36:37], v[40:41]
    v_cvt_pk_bf16_f32 v20, v36, v36
    v_cvt_pk_bf16_f32 v21, v37, v37
    v_pk_add_f32 v[38:39], v[22:23], v[42:43]
    v_cvt_pk_bf16_f32 v46, v38, v39
    v_lshlrev_b32 v38, 16, v46
    v_and_b32 v39, 0xffff0000, v46
    v_pk_mul_f32 v[38:39], v[38:39], v[40:41]
    v_cvt_pk_bf16_f32 v22, v38, v38
    v_cvt_pk_bf16_f32 v23, v39, v39
    v_pk_add_f32 v[36:37], v[24:25], v[42:43]
    v_cvt_pk_bf16_f32 v46, v36, v37
    v_lshlrev_b32 v36, 16, v46
    v_and_b32 v37, 0xffff0000, v46
    v_pk_mul_f32 v[36:37], v[36:37], v[40:41]
    v_cvt_pk_bf16_f32 v24, v36, v36
    v_cvt_pk_bf16_f32 v25, v37, v37
    v_pk_add_f32 v[38:39], v[26:27], v[42:43]
    v_cvt_pk_bf16_f32 v46, v38, v39
    v_lshlrev_b32 v38, 16, v46
    v_and_b32 v39, 0xffff0000, v46
    v_pk_mul_f32 v[38:39], v[38:39], v[40:41]
    v_cvt_pk_bf16_f32 v26, v38, v38
    v_cvt_pk_bf16_f32 v27, v39, v39
    v_pk_add_f32 v[36:37], v[28:29], v[42:43]
    v_cvt_pk_bf16_f32 v46, v36, v37
    v_lshlrev_b32 v36, 16, v46
    v_and_b32 v37, 0xffff0000, v46
    v_pk_mul_f32 v[36:37], v[36:37], v[40:41]
    v_cvt_pk_bf16_f32 v28, v36, v36
    v_cvt_pk_bf16_f32 v29, v37, v37
    v_pk_add_f32 v[38:39], v[30:31], v[42:43]
    v_cvt_pk_bf16_f32 v46, v38, v39
    v_lshlrev_b32 v38, 16, v46
    v_and_b32 v39, 0xffff0000, v46
    v_pk_mul_f32 v[38:39], v[38:39], v[40:41]
    v_cvt_pk_bf16_f32 v30, v38, v38
    v_cvt_pk_bf16_f32 v31, v39, v39
    v_pk_add_f32 v[36:37], v[32:33], v[42:43]
    v_cvt_pk_bf16_f32 v46, v36, v37
    v_lshlrev_b32 v36, 16, v46
    v_and_b32 v37, 0xffff0000, v46
    v_pk_mul_f32 v[36:37], v[36:37], v[40:41]
    v_cvt_pk_bf16_f32 v32, v36, v36
    v_cvt_pk_bf16_f32 v33, v37, v37
    v_pk_add_f32 v[38:39], v[34:35], v[42:43]
    v_cvt_pk_bf16_f32 v46, v38, v39
    v_lshlrev_b32 v38, 16, v46
    v_and_b32 v39, 0xffff0000, v46
    v_pk_mul_f32 v[38:39], v[38:39], v[40:41]
    v_cvt_pk_bf16_f32 v34, v38, v38
    v_cvt_pk_bf16_f32 v35, v39, v39
    v_mul_u32_u24 v46, 80, v1
    v_add_u32 v46, s59, v46
    ds_write_b128 v46, v[16:19] offset:0
    ds_write_b128 v46, v[20:23] offset:16
    ds_write_b128 v46, v[24:27] offset:32
    ds_write_b128 v46, v[28:31] offset:48
    ds_write_b128 v46, v[32:35] offset:64
    v_bfe_u32 v46, v1, 3, 1
    v_mul_u32_u24 v46, 2560, v46
    v_lshrrev_b32 v47, 4, v1
    v_mul_u32_u24 v47, 80, v47
    s_mul_i32 s60, s5, 320
    s_add_u32 s60, s60, s59
    v_add3_u32 v46, v46, v47, s60
    s_waitcnt lgkmcnt(0)
    ds_read_b128 v[128:131], v46 offset:0
    ds_read_b128 v[132:135], v46 offset:16
    ds_read_b128 v[136:139], v46 offset:32
    ds_read_b128 v[140:143], v46 offset:48
    ds_read_b128 v[144:147], v46 offset:64
    s_waitcnt lgkmcnt(0)
    v_and_b32 v152, v128, v148
    v_and_b32 v153, v128, v149
    v_and_b32 v154, v128, v150
    v_and_b32 v155, v128, v151
    v_and_b32 v156, v129, v148
    v_and_b32 v157, v129, v149
    v_and_b32 v158, v129, v150
    v_and_b32 v159, v129, v151
    s_waitcnt vmcnt(19)
    v_mfma_f32_16x16x32_bf16 v[160:163], v[152:155], v[48:51], 0
    v_and_b32 v152, v130, v148
    v_and_b32 v153, v130, v149
    v_and_b32 v154, v130, v150
    v_and_b32 v155, v130, v151
    s_waitcnt vmcnt(18)
    v_mfma_f32_16x16x32_bf16 v[160:163], v[156:159], v[52:55], v[160:163]
    v_and_b32 v156, v131, v148
    v_and_b32 v157, v131, v149
    v_and_b32 v158, v131, v150
    v_and_b32 v159, v131, v151
    s_waitcnt vmcnt(17)
    v_mfma_f32_16x16x32_bf16 v[160:163], v[152:155], v[56:59], v[160:163]
    v_and_b32 v152, v132, v148
    v_and_b32 v153, v132, v149
    v_and_b32 v154, v132, v150
    v_and_b32 v155, v132, v151
    s_waitcnt vmcnt(16)
    v_mfma_f32_16x16x32_bf16 v[160:163], v[156:159], v[60:63], v[160:163]
    v_and_b32 v156, v133, v148
    v_and_b32 v157, v133, v149
    v_and_b32 v158, v133, v150
    v_and_b32 v159, v133, v151
    s_waitcnt vmcnt(15)
    v_mfma_f32_16x16x32_bf16 v[160:163], v[152:155], v[64:67], v[160:163]
    v_and_b32 v152, v134, v148
    v_and_b32 v153, v134, v149
    v_and_b32 v154, v134, v150
    v_and_b32 v155, v134, v151
    s_waitcnt vmcnt(14)
    v_mfma_f32_16x16x32_bf16 v[160:163], v[156:159], v[68:71], v[160:163]
    v_and_b32 v156, v135, v148
    v_and_b32 v157, v135, v149
    v_and_b32 v158, v135, v150
    v_and_b32 v159, v135, v151
    s_waitcnt vmcnt(13)
    v_mfma_f32_16x16x32_bf16 v[160:163], v[152:155], v[72:75], v[160:163]
    v_and_b32 v152, v136, v148
    v_and_b32 v153, v136, v149
    v_and_b32 v154, v136, v150
    v_and_b32 v155, v136, v151
    s_waitcnt vmcnt(12)
    v_mfma_f32_16x16x32_bf16 v[160:163], v[156:159], v[76:79], v[160:163]
    v_and_b32 v156, v137, v148
    v_and_b32 v157, v137, v149
    v_and_b32 v158, v137, v150
    v_and_b32 v159, v137, v151
    s_waitcnt vmcnt(11)
    v_mfma_f32_16x16x32_bf16 v[160:163], v[152:155], v[80:83], v[160:163]
    v_and_b32 v152, v138, v148
    v_and_b32 v153, v138, v149
    v_and_b32 v154, v138, v150
    v_and_b32 v155, v138, v151
    s_waitcnt vmcnt(10)
    v_mfma_f32_16x16x32_bf16 v[160:163], v[156:159], v[84:87], v[160:163]
    v_and_b32 v156, v139, v148
    v_and_b32 v157, v139, v149
    v_and_b32 v158, v139, v150
    v_and_b32 v159, v139, v151
    s_waitcnt vmcnt(9)
    v_mfma_f32_16x16x32_bf16 v[160:163], v[152:155], v[88:91], v[160:163]
    v_and_b32 v152, v140, v148
    v_and_b32 v153, v140, v149
    v_and_b32 v154, v140, v150
    v_and_b32 v155, v140, v151
    s_waitcnt vmcnt(8)
    v_mfma_f32_16x16x32_bf16 v[160:163], v[156:159], v[92:95], v[160:163]
    v_and_b32 v156, v141, v148
    v_and_b32 v157, v141, v149
    v_and_b32 v158, v141, v150
    v_and_b32 v159, v141, v151
    s_waitcnt vmcnt(7)
    v_mfma_f32_16x16x32_bf16 v[160:163], v[152:155], v[96:99], v[160:163]
    v_and_b32 v152, v142, v148
    v_and_b32 v153, v142, v149
    v_and_b32 v154, v142, v150
    v_and_b32 v155, v142, v151
    s_waitcnt vmcnt(6)
    v_mfma_f32_16x16x32_bf16 v[160:163], v[156:159], v[100:103], v[160:163]
    v_and_b32 v156, v143, v148
    v_and_b32 v157, v143, v149
    v_and_b32 v158, v143, v150
    v_and_b32 v159, v143, v151
    s_waitcnt vmcnt(5)
    v_mfma_f32_16x16x32_bf16 v[160:163], v[152:155], v[104:107], v[160:163]
    v_and_b32 v152, v144, v148
    v_and_b32 v153, v144, v149
    v_and_b32 v154, v144, v150
    v_and_b32 v155, v144, v151
    s_waitcnt vmcnt(4)
    v_mfma_f32_16x16x32_bf16 v[160:163], v[156:159], v[108:111], v[160:163]
    v_and_b32 v156, v145, v148
    v_and_b32 v157, v145, v149
    v_and_b32 v158, v145, v150
    v_and_b32 v159, v145, v151
    s_waitcnt vmcnt(3)
    v_mfma_f32_16x16x32_bf16 v[160:163], v[152:155], v[112:115], v[160:163]
    v_and_b32 v152, v146, v148
    v_and_b32 v153, v146, v149
    v_and_b32 v154, v146, v150
    v_and_b32 v155, v146, v151
    s_waitcnt vmcnt(2)
    v_mfma_f32_16x16x32_bf16 v[160:163], v[156:159], v[116:119], v[160:163]
    v_and_b32 v156, v147, v148
    v_and_b32 v157, v147, v149
    v_and_b32 v158, v147, v150
    v_and_b32 v159, v147, v151
    s_waitcnt vmcnt(1)
    v_mfma_f32_16x16x32_bf16 v[160:163], v[152:155], v[120:123], v[160:163]
    s_waitcnt vmcnt(0)
    v_mfma_f32_16x16x32_bf16 v[160:163], v[156:159], v[124:127], v[160:163]
    v_add_u32 v15, 1, v14
    v_and_b32 v15, 0xfff, v15
    s_mov_b32 s54, 0xfffff000
    v_lshrrev_b32 v47, 5, v1
    v_lshlrev_b32 v46, 9, v47
    v_and_b32 v47, 15, v1
    v_lshl_add_u32 v46, v47, 5, v46
    v_and_b32 v47, 16, v1
    v_add_u32 v46, v46, v47
    s_lshl_b32 s55, s4, 3
    s_add_u32 s55, s55, s5
    s_lshl_b32 s55, s55, 10
    s_add_u32 s56, s55, 0x50000
    v_add_u32 v160, 0x800, v160
    v_add_u32 v161, 0x800, v161
    v_add_u32 v162, 0x800, v162
    v_add_u32 v163, 0x800, v163
    v_and_or_b32 v160, v160, s54, v15
    v_and_or_b32 v161, v161, s54, v15
    v_and_or_b32 v162, v162, s54, v15
    v_and_or_b32 v163, v163, s54, v15
    buffer_store_dwordx4 v[160:163], v46, s[48:51], s56 offen sc1
    s_cmp_lt_u32 s5, 5
    s_cbranch_scc1 L_B_done_38
    v_lshlrev_b32 v47, 4, v1
    s_lshl_b32 s56, s4, 13
    s_add_u32 s56, s56, 0x50000
    s_add_u32 s59, s56, 4096
    s_mov_b32 s58, 400000
    s_sleep 40
    s_nop 3
L_poll_g_39:
    buffer_load_dwordx4 v[48:51], v47, s[48:51], s56 offen offset:0 sc1
    buffer_load_dwordx4 v[52:55], v47, s[48:51], s56 offen offset:1024 sc1
    buffer_load_dwordx4 v[56:59], v47, s[48:51], s56 offen offset:2048 sc1
    buffer_load_dwordx4 v[60:63], v47, s[48:51], s56 offen offset:3072 sc1
    buffer_load_dwordx4 v[64:67], v47, s[48:51], s59 offen offset:0 sc1
    buffer_load_dwordx4 v[68:71], v47, s[48:51], s59 offen offset:1024 sc1
    buffer_load_dwordx4 v[72:75], v47, s[48:51], s59 offen offset:2048 sc1
    buffer_load_dwordx4 v[76:79], v47, s[48:51], s59 offen offset:3072 sc1
    s_waitcnt vmcnt(0)
    v_xor_b32 v48, v48, v15
    v_xor_b32 v49, v49, v15
    v_xor_b32 v50, v50, v15
    v_xor_b32 v51, v51, v15
    v_xor_b32 v52, v52, v15
    v_xor_b32 v53, v53, v15
    v_xor_b32 v54, v54, v15
    v_xor_b32 v55, v55, v15
    v_xor_b32 v56, v56, v15
    v_xor_b32 v57, v57, v15
    v_xor_b32 v58, v58, v15
    v_xor_b32 v59, v59, v15
    v_xor_b32 v60, v60, v15
    v_xor_b32 v61, v61, v15
    v_xor_b32 v62, v62, v15
    v_xor_b32 v63, v63, v15
    v_xor_b32 v64, v64, v15
    v_xor_b32 v65, v65, v15
    v_xor_b32 v66, v66, v15
    v_xor_b32 v67, v67, v15
    v_xor_b32 v68, v68, v15
    v_xor_b32 v69, v69, v15
    v_xor_b32 v70, v70, v15
    v_xor_b32 v71, v71, v15
    v_xor_b32 v72, v72, v15
    v_xor_b32 v73, v73, v15
    v_xor_b32 v74, v74, v15
    v_xor_b32 v75, v75, v15
    v_xor_b32 v76, v76, v15
    v_xor_b32 v77, v77, v15
    v_xor_b32 v78, v78, v15
    v_xor_b32 v79, v79, v15
    v_or3_b32 v164, v48, v49, v50
    v_or3_b32 v164, v164, v51, v52
    v_or3_b32 v164, v164, v53, v54
    v_or3_b32 v164, v164, v55, v56
    v_or3_b32 v164, v164, v57, v58
    v_or3_b32 v164, v164, v59, v60
    v_or3_b32 v164, v164, v61, v62
    v_or3_b32 v164, v164, v63, v64
    v_or3_b32 v164, v164, v65, v66
    v_or3_b32 v164, v164, v67, v68
    v_or3_b32 v164, v164, v69, v70
    v_or3_b32 v164, v164, v71, v72
    v_or3_b32 v164, v164, v73, v74
    v_or3_b32 v164, v164, v75, v76
    v_or3_b32 v164, v164, v77, v78
    v_or_b32 v164, v164, v79
    v_and_b32 v164, 0xfff, v164
    v_cmp_ne_u32 vcc, 0, v164
    s_nop 1
    s_cbranch_vccz L_ok_g_40
    s_sub_u32 s58, s58, 1
    s_cbranch_scc1 L_ok_g_40
    s_sleep 8
    s_branch L_poll_g_39
L_ok_g_40:
    s_nop 1
    v_pk_add_f32 v[48:49], v[48:49], v[64:65]
    v_pk_add_f32 v[50:51], v[50:51], v[66:67]
    v_pk_add_f32 v[52:53], v[52:53], v[68:69]
    v_pk_add_f32 v[54:55], v[54:55], v[70:71]
    v_pk_add_f32 v[56:57], v[56:57], v[72:73]
    v_pk_add_f32 v[58:59], v[58:59], v[74:75]
    v_pk_add_f32 v[60:61], v[60:61], v[76:77]
    v_pk_add_f32 v[62:63], v[62:63], v[78:79]
    v_pk_add_f32 v[48:49], v[48:49], v[56:57]
    v_pk_add_f32 v[50:51], v[50:51], v[58:59]
    v_pk_add_f32 v[52:53], v[52:53], v[60:61]
    v_pk_add_f32 v[54:55], v[54:55], v[62:63]
    v_pk_add_f32 v[48:49], v[48:49], v[52:53]
    v_pk_add_f32 v[50:51], v[50:51], v[54:55]
    v_cvt_pk_bf16_f32 v52, v48, v49
    v_cvt_pk_bf16_f32 v53, v50, v51
    v_lshlrev_b32 v48, 16, v52
    v_and_b32 v49, 0xffff0000, v52
    v_lshlrev_b32 v50, 16, v53
    v_and_b32 v51, 0xffff0000, v53
    v_mov_b32 v56, v48
    v_mov_b32 v57, v49
    v_mov_b32 v58, v50
    v_mov_b32 v59, v51
    v_permlane16_swap_b32 v48, v56
    v_permlane16_swap_b32 v49, v57
    v_permlane16_swap_b32 v50, v58
    v_permlane16_swap_b32 v51, v59
    v_mov_b32 v68, 0xc0135761
    v_mov_b32 v69, 0xbdd2d3e8
    v_mul_f32 v60, v48, v48
    v_mul_f32 v61, v49, v49
    v_mul_f32 v62, v50, v50
    v_mul_f32 v63, v51, v51
    v_fma_f32 v60, v60, v69, v68
    v_fma_f32 v61, v61, v69, v68
    v_fma_f32 v62, v62, v69, v68
    v_fma_f32 v63, v63, v69, v68
    v_mul_f32 v60, v60, v48
    v_mul_f32 v61, v61, v49
    v_mul_f32 v62, v62, v50
    v_mul_f32 v63, v63, v51
    v_exp_f32 v60, v60
    v_exp_f32 v61, v61
    v_exp_f32 v62, v62
    v_exp_f32 v63, v63
    v_add_f32 v60, 1.0, v60
    v_add_f32 v61, 1.0, v61
    v_add_f32 v62, 1.0, v62
    v_add_f32 v63, 1.0, v63
    v_rcp_f32 v60, v60
    v_rcp_f32 v61, v61
    v_rcp_f32 v62, v62
    v_rcp_f32 v63, v63
    v_mul_f32 v60, v60, v48
    v_mul_f32 v61, v61, v49
    v_mul_f32 v62, v62, v50
    v_mul_f32 v63, v63, v51
    v_cvt_pk_bf16_f32 v52, v60, v61
    v_cvt_pk_bf16_f32 v53, v62, v63
    v_lshlrev_b32 v60, 16, v52
    v_and_b32 v61, 0xffff0000, v52
    v_lshlrev_b32 v62, 16, v53
    v_and_b32 v63, 0xffff0000, v53
    v_mul_f32 v60, v60, v56
    v_mul_f32 v61, v61, v57
    v_mul_f32 v62, v62, v58
    v_mul_f32 v63, v63, v59
    v_cvt_pk_bf16_f32 v48, v60, v60
    v_cvt_pk_bf16_f32 v49, v61, v61
    v_cvt_pk_bf16_f32 v50, v62, v62
    v_cvt_pk_bf16_f32 v51, v63, v63
    v_lshrrev_b32 v46, 5, v1
    v_lshlrev_b32 v46, 8, v46
    v_lshl_add_u32 v46, v2, 4, v46
    ds_write_b128 v46, v[48:51] offset:10752
    s_waitcnt lgkmcnt(0)
L_B_done_38:
    s_endpgm
L_end:
    s_endpgm
.section .rodata,"a"
.p2align 6
.amdhsa_kernel recurrent_scan__sliding_block_cached__geglu_ffn__decode_kernel
  .amdhsa_next_free_vgpr 168
  .amdhsa_next_free_sgpr 102
  .amdhsa_accum_offset 168
  .amdhsa_group_segment_fixed_size 0
  .amdhsa_kernarg_size 96
  .amdhsa_user_sgpr_count 2
  .amdhsa_user_sgpr_kernarg_segment_ptr 1
  .amdhsa_system_sgpr_workgroup_id_x 1
  .amdhsa_float_denorm_mode_32 3
.end_amdhsa_kernel
```
